```python
import torch

def _softmax(x, axis=-1):
    return torch.softmax(x, dim=axis)
def _gelu(x):
    return torch.nn.functional.gelu(x, approximate="tanh")
def _silu(x):
    return torch.nn.functional.silu(x)
def _sigmoid(x):
    return torch.sigmoid(x)
def _layernorm(x, axis=-1, eps=1e-5):
    m = x.mean(dim=axis, keepdim=True)
    v = x.var(dim=axis, keepdim=True, unbiased=False)
    return (x - m) / torch.sqrt(v + eps)
def _scatter_add(tgt, idx, src, axis=0):
    return tgt.clone().index_add_(axis, idx, src)
def _segment_sum(src, seg, n):
    out = torch.zeros((n,) + src.shape[1:], dtype=src.dtype)
    return out.index_add_(0, seg, src)
def _pad(x, pw):
    flat = tuple(v for pair in reversed(pw) for v in pair)
    return torch.nn.functional.pad(x, flat)

kernel_name = 'standalone__geglu_ffn__sampling'

def setup_inputs():

    _w = (lambda a: (lambda t: t.to(torch.bfloat16) if t.is_floating_point() else t)(torch.as_tensor(a)))
    B, S, D, F = 32, 32, 576, 4608
    return {
        "x": _w((lambda *s: torch.randn(*s, dtype=torch.bfloat16) * 0.05)(B, S, D)),
        "w_gate": _w((lambda *s: torch.randn(*s, dtype=torch.bfloat16) * 0.05)(D, F)),
        "w_up": _w((lambda *s: torch.randn(*s, dtype=torch.bfloat16) * 0.05)(D, F)),
        "w_down": _w((lambda *s: torch.randn(*s, dtype=torch.bfloat16) * 0.05)(F, D)),
    }

def reference(x, w_gate, w_up, w_down):
    return (_gelu(x @ w_gate) * (x @ w_up)) @ w_down
```

```asm
; @launch grid=(256,1,1) block=(512,1,1) lds=159872
.amdgcn_target "amdgcn-amd-amdhsa--gfx950"
.text
.globl standalone__geglu_ffn__sampling_kernel
.p2align 8
.type standalone__geglu_ffn__sampling_kernel,@function
standalone__geglu_ffn__sampling_kernel:
  s_cmp_ge_u32 s2, 256
  s_cbranch_scc1 L_end
  s_load_dwordx8 s[4:11], s[0:1], 0
  s_load_dwordx4 s[12:15], s[0:1], 32
  s_load_dwordx2 s[16:17], s[0:1], 48
  v_lshrrev_b32 v1, 6, v0
  v_and_b32 v0, 63, v0
  v_readfirstlane_b32 s18, v1
  s_and_b32 s19, s2, 7
  s_lshr_b32 s20, s2, 3
  s_lshr_b32 s21, s20, 2
  s_and_b32 s20, s20, 3
  s_add_u32 s23, s20, s21
  s_and_b32 s22, s23, 3
  s_cmp_lt_u32 s18, 4
  s_cbranch_scc1 L_compute
  s_mov_b32 s24, 811796016
  s_mov_b32 s25, 774
  s_lshl_b32 s23, s23, 2
  s_lshr_b64 s[24:25], s[24:25], s23
  s_and_b32 s23, s24, 15
  s_add_u32 s23, s23, s19
  s_cmp_ge_u32 s23, 9
  s_cselect_b32 s24, 9, 0
  s_sub_u32 s23, s23, s24
  s_sub_u32 s34, s18, 4
  s_lshl_b32 s38, s21, 7
  s_lshl_b32 s39, s34, 5
  s_add_u32 s38, s38, s39
  v_lshrrev_b32 v30, 3, v0
  v_add_u32 v30, s38, v30
  v_mul_u32_u24 v30, 1152, v30
  v_lshrrev_b32 v31, 4, v0
  v_xor_b32 v31, v31, v0
  v_and_b32 v31, 7, v31
  v_lshl_add_u32 v5, v31, 4, v30
  v_xor_b32 v31, 4, v31
  v_lshl_add_u32 v6, v31, 4, v30
  v_add_u32 v6, 8192, v6
  v_add_u32 v7, 16384, v5
  v_add_u32 v8, 16384, v6
  s_mul_i32 s35, s19, 1152
  s_mul_i32 s38, s20, 288
  s_add_u32 s38, s38, s35
  s_and_b32 s39, s20, 1
  s_lshl_b32 s33, s39, 8
  s_lshl_b32 s32, s39, 5
  s_sub_u32 s39, s38, s33
  s_add_u32 s38, s38, s32
  v_mov_b32 v34, s38
  v_mov_b32 v35, s39
  s_lshl_b32 s36, s34, 6
  v_add_u32 v30, s36, v0
  v_mul_u32_u24 v31, 3641, v30
  v_lshrrev_b32 v12, 16, v31
  v_mul_u32_u24 v31, 18, v12
  v_sub_u32 v13, v30, v31
  v_and_b32 v33, 0x13, v12
  v_bfe_u32 v36, v12, 2, 1
  v_lshl_or_b32 v33, v36, 3, v33
  v_bfe_u32 v36, v12, 3, 1
  v_cmp_lt_u32 vcc, 15, v13
  v_lshl_or_b32 v33, v36, 2, v33
  v_mul_u32_u24 v33, 9216, v33
  v_cndmask_b32 v36, v34, v35, vcc
  v_lshl_add_u32 v33, v13, 4, v33
  v_add_u32 v2, v36, v33
  v_add_u32 v30, 256, v30
  v_mul_u32_u24 v31, 3641, v30
  v_lshrrev_b32 v14, 16, v31
  v_mul_u32_u24 v31, 18, v14
  v_sub_u32 v15, v30, v31
  v_and_b32 v33, 0x13, v14
  v_bfe_u32 v36, v14, 2, 1
  v_lshl_or_b32 v33, v36, 3, v33
  v_bfe_u32 v36, v14, 3, 1
  v_cmp_lt_u32 vcc, 15, v15
  v_lshl_or_b32 v33, v36, 2, v33
  v_mul_u32_u24 v33, 9216, v33
  v_cndmask_b32 v36, v34, v35, vcc
  v_lshl_add_u32 v33, v15, 4, v33
  v_add_u32 v3, v36, v33
  v_add_u32 v30, 512, v0
  v_mul_u32_u24 v31, 3641, v30
  v_lshrrev_b32 v16, 16, v31
  v_mul_u32_u24 v31, 18, v16
  v_sub_u32 v17, v30, v31
  v_and_b32 v33, 0x13, v16
  v_bfe_u32 v36, v16, 2, 1
  v_lshl_or_b32 v33, v36, 3, v33
  v_bfe_u32 v36, v16, 3, 1
  v_cmp_lt_u32 vcc, 15, v17
  v_lshl_or_b32 v33, v36, 2, v33
  v_mul_u32_u24 v33, 9216, v33
  v_cndmask_b32 v36, v34, v35, vcc
  v_lshl_add_u32 v33, v17, 4, v33
  v_add_u32 v4, v36, v33
  s_mul_i32 s48, s23, 589824
  s_lshl_b32 s49, s23, 7
  s_lshl_b32 s32, s34, 10
  s_and_b32 s33, s34, 1
  s_mul_i32 s33, s33, 9216
  s_add_u32 s33, s33, 8192
  s_lshr_b32 s35, s34, 1
  s_lshl_b32 s36, s34, 12
  s_add_u32 s36, s36, 110592
  s_mov_b32 s50, 0
  s_mov_b32 s51, s36
  s_add_u32 s37, s36, 49152
  s_bitcmp1_b32 s34, 0
  s_waitcnt lgkmcnt(0)
  s_cselect_b32 s56, s8, s6
  s_cselect_b32 s57, s9, s7
  s_mov_b32 s58, 5308416
  s_mov_b32 s59, 0x00020000
  s_mov_b32 s24, s4
  s_mov_b32 s25, s5
  s_mov_b32 s26, 1179648
  s_mov_b32 s27, 0x00020000
  s_mov_b32 s40, s6
  s_mov_b32 s41, s7
  s_mov_b32 s42, 5308416
  s_mov_b32 s43, 0x00020000
  s_mov_b32 s44, s8
  s_mov_b32 s45, s9
  s_mov_b32 s46, 5308416
  s_mov_b32 s47, 0x00020000
  s_mov_b32 s53, 9
  s_branch L_lf0
L_lloop:
  s_waitcnt vmcnt(4)
  s_barrier
L_lf0:
  s_mov_b32 m0, s51
  s_add_u32 s51, s51, 16384
  buffer_load_dwordx4 v5, s[24:27], s49 offen offset:0 lds
  buffer_load_dwordx4 v6, s[24:27], s49 offen offset:1024 lds
  buffer_load_dwordx4 v7, s[24:27], s49 offen offset:2048 lds
  buffer_load_dwordx4 v8, s[24:27], s49 offen offset:3072 lds
  s_cmp_eq_u32 s51, s37
  s_cselect_b32 s51, s36, s51
  s_add_u32 s49, s49, 128
  s_cmp_eq_u32 s49, 1152
  s_cselect_b32 s49, 0, s49
  s_add_u32 s52, s50, s32
  s_add_u32 m0, s52, 0
  s_nop 0
  buffer_load_dwordx4 v2, s[40:43], s48 offen lds
  s_add_u32 m0, s52, 4096
  s_nop 0
  buffer_load_dwordx4 v3, s[40:43], s48 offen lds
  s_add_u32 m0, s52, 9216
  s_nop 0
  buffer_load_dwordx4 v2, s[44:47], s48 offen lds
  s_add_u32 m0, s52, 13312
  s_nop 0
  buffer_load_dwordx4 v3, s[44:47], s48 offen lds
  s_cmp_eq_u32 s35, 0
  s_cbranch_scc0 L_p81
  s_add_u32 m0, s50, s33
  s_nop 0
  buffer_load_dwordx4 v4, s[56:59], s48 offen lds
L_p81:
  s_add_u32 s48, s48, 294912
  s_cmp_eq_u32 s48, 5308416
  s_cselect_b32 s48, 0, s48
  s_add_u32 s50, s50, 18432
  s_cmp_eq_u32 s50, 110592
  s_cselect_b32 s50, 0, s50
  s_cmp_eq_u32 s53, 9
  s_cbranch_scc1 L_lf1
  s_waitcnt vmcnt(8)
  s_barrier
L_lf1:
  s_add_u32 s52, s50, s32
  s_add_u32 m0, s52, 0
  s_nop 0
  buffer_load_dwordx4 v2, s[40:43], s48 offen lds
  s_add_u32 m0, s52, 4096
  s_nop 0
  buffer_load_dwordx4 v3, s[40:43], s48 offen lds
  s_add_u32 m0, s52, 9216
  s_nop 0
  buffer_load_dwordx4 v2, s[44:47], s48 offen lds
  s_add_u32 m0, s52, 13312
  s_nop 0
  buffer_load_dwordx4 v3, s[44:47], s48 offen lds
  s_cmp_eq_u32 s35, 1
  s_cbranch_scc0 L_p82
  s_add_u32 m0, s50, s33
  s_nop 0
  buffer_load_dwordx4 v4, s[56:59], s48 offen lds
L_p82:
  s_add_u32 s48, s48, 294912
  s_cmp_eq_u32 s48, 5308416
  s_cselect_b32 s48, 0, s48
  s_add_u32 s50, s50, 18432
  s_cmp_eq_u32 s50, 110592
  s_cselect_b32 s50, 0, s50
  s_sub_u32 s53, s53, 1
  s_cmp_lg_u32 s53, 0
  s_cbranch_scc1 L_lloop
  s_mul_i32 s53, s22, 288
  s_lshl_b32 s62, s34, 6
  v_add_u32 v30, s62, v0
  v_mul_u32_u24 v31, 3641, v30
  v_lshrrev_b32 v12, 16, v31
  v_mul_u32_u24 v31, 18, v12
  v_sub_u32 v32, v30, v31
  v_mul_u32_u24 v31, 1152, v12
  v_lshl_add_u32 v31, v32, 4, v31
  v_add_u32 v9, s53, v31
  v_add_u32 v30, 192, v30
  v_mul_u32_u24 v31, 3641, v30
  v_lshrrev_b32 v14, 16, v31
  v_mul_u32_u24 v31, 18, v14
  v_sub_u32 v32, v30, v31
  v_mul_u32_u24 v31, 1152, v14
  v_lshl_add_u32 v31, v32, 4, v31
  v_add_u32 v10, s53, v31
  v_add_u32 v30, 192, v30
  v_mul_u32_u24 v31, 3641, v30
  v_lshrrev_b32 v16, 16, v31
  v_mul_u32_u24 v31, 18, v16
  v_sub_u32 v32, v30, v31
  v_mul_u32_u24 v31, 1152, v16
  v_lshl_add_u32 v31, v32, 4, v31
  v_add_u32 v11, s53, v31
  v_mov_b32 v20, 159744
  v_mov_b32 v21, 1
  v_mov_b32 v22, 0
  s_lshl_b32 s53, s34, 2
  v_add_u32 v26, s53, v20
  s_mov_b32 s28, s14
  s_mov_b32 s29, s15
  s_mov_b32 s30, 256
  s_mov_b32 s31, 0x00020000
  s_lshr_b32 s62, s2, 3
  s_lshl_b32 s62, s62, 2
  s_add_u32 s62, s62, s34
  s_mul_i32 s55, s62, 5184
  s_mul_i32 s53, s19, 663552
  s_add_u32 s55, s55, s53
  v_min_u32 v18, 41, v0
  v_lshlrev_b32 v18, 7, v18
  v_add_u32 v18, s55, v18
  s_mov_b32 s96, s10
  s_mov_b32 s97, s11
  s_mov_b32 s98, 5308416
  s_mov_b32 s99, 0x00020000
  s_mov_b32 s40, s10
  s_mov_b32 s41, s11
  s_mov_b32 s42, 5308416
  s_mov_b32 s43, 0x00020000
  s_mul_i32 s49, s19, 663552
  buffer_load_dword v23, v22, s[28:31], 0 offen sc1
  buffer_load_dword v17, v18, s[96:99], 0 offen
  s_waitcnt vmcnt(6)
  s_barrier
  s_cmp_eq_u32 s34, 3
  s_cbranch_scc1 L_poller
  s_add_u32 s52, s20, 0
  s_and_b32 s52, s52, 3
  s_mul_i32 s52, s52, 9
  s_add_u32 s52, s52, 1
  s_lshr_b32 s52, s52, 1
  s_mul_i32 s48, s52, 36864
  s_add_u32 s48, s48, s49
  s_add_u32 s52, s20, 0
  s_and_b32 s52, s52, 3
  s_mul_i32 s52, s52, 9
  s_add_u32 s52, s52, 3
  s_lshr_b32 s52, s52, 1
  s_mul_i32 s54, s52, 36864
  s_add_u32 s54, s54, s49
  s_add_u32 m0, s32, 0
  s_nop 0
  buffer_load_dwordx4 v9, s[40:43], s48 offen lds
  s_add_u32 m0, s32, 3072
  s_nop 0
  buffer_load_dwordx4 v10, s[40:43], s48 offen lds
  s_add_u32 m0, s32, 6144
  s_nop 0
  buffer_load_dwordx4 v11, s[40:43], s48 offen lds
  s_add_u32 m0, s32, 9216
  s_nop 0
  buffer_load_dwordx4 v9, s[40:43], s54 offen lds
  s_add_u32 m0, s32, 12288
  s_nop 0
  buffer_load_dwordx4 v10, s[40:43], s54 offen lds
  s_add_u32 m0, s32, 15360
  s_nop 0
  buffer_load_dwordx4 v11, s[40:43], s54 offen lds
  s_waitcnt vmcnt(7)
  s_barrier
  ds_read_b32 v23, v20
  s_add_u32 s52, s20, 0
  s_and_b32 s52, s52, 3
  s_mul_i32 s52, s52, 9
  s_add_u32 s52, s52, 5
  s_lshr_b32 s52, s52, 1
  s_mul_i32 s48, s52, 36864
  s_add_u32 s48, s48, s49
  s_add_u32 s52, s20, 0
  s_and_b32 s52, s52, 3
  s_mul_i32 s52, s52, 9
  s_add_u32 s52, s52, 7
  s_lshr_b32 s52, s52, 1
  s_mul_i32 s54, s52, 36864
  s_add_u32 s54, s54, s49
  s_add_u32 m0, s32, 18432
  s_nop 0
  buffer_load_dwordx4 v9, s[40:43], s48 offen lds
  s_add_u32 m0, s32, 21504
  s_nop 0
  buffer_load_dwordx4 v10, s[40:43], s48 offen lds
  s_add_u32 m0, s32, 24576
  s_nop 0
  buffer_load_dwordx4 v11, s[40:43], s48 offen lds
  s_add_u32 m0, s32, 27648
  s_nop 0
  buffer_load_dwordx4 v9, s[40:43], s54 offen lds
  s_add_u32 m0, s32, 30720
  s_nop 0
  buffer_load_dwordx4 v10, s[40:43], s54 offen lds
  s_add_u32 m0, s32, 33792
  s_nop 0
  buffer_load_dwordx4 v11, s[40:43], s54 offen lds
  s_mov_b32 s28, s16
  s_mov_b32 s29, s17
  s_mov_b32 s30, 33816576
  s_mov_b32 s31, 0x00020000
  s_add_u32 s52, s20, 1
  s_and_b32 s52, s52, 3
  s_mul_i32 s52, s52, 9
  s_add_u32 s52, s52, 1
  s_lshr_b32 s52, s52, 1
  s_mul_i32 s48, s52, 36864
  s_add_u32 s48, s48, s49
  s_add_u32 s52, s20, 2
  s_and_b32 s52, s52, 3
  s_mul_i32 s52, s52, 9
  s_add_u32 s52, s52, 1
  s_lshr_b32 s52, s52, 1
  s_mul_i32 s54, s52, 36864
  s_add_u32 s54, s54, s49
  s_add_u32 m0, s32, 36864
  s_nop 0
  buffer_load_dwordx4 v9, s[40:43], s48 offen lds
  s_add_u32 m0, s32, 39936
  s_nop 0
  buffer_load_dwordx4 v10, s[40:43], s48 offen lds
  s_add_u32 m0, s32, 43008
  s_nop 0
  buffer_load_dwordx4 v11, s[40:43], s48 offen lds
  s_add_u32 m0, s32, 46080
  s_nop 0
  buffer_load_dwordx4 v9, s[40:43], s54 offen lds
  s_add_u32 m0, s32, 49152
  s_nop 0
  buffer_load_dwordx4 v10, s[40:43], s54 offen lds
  s_add_u32 m0, s32, 52224
  s_nop 0
  buffer_load_dwordx4 v11, s[40:43], s54 offen lds
  s_waitcnt vmcnt(6)
  s_mov_b64 exec, 1
  ds_add_u32 v20, v21 offset:64
  s_mov_b64 exec, -1
  s_add_u32 s52, s20, 3
  s_and_b32 s52, s52, 3
  s_mul_i32 s52, s52, 9
  s_add_u32 s52, s52, 1
  s_lshr_b32 s52, s52, 1
  s_mul_i32 s48, s52, 36864
  s_add_u32 s48, s48, s49
  s_add_u32 s52, s20, 1
  s_and_b32 s52, s52, 3
  s_mul_i32 s52, s52, 9
  s_add_u32 s52, s52, 3
  s_lshr_b32 s52, s52, 1
  s_mul_i32 s54, s52, 36864
  s_add_u32 s54, s54, s49
  s_add_u32 m0, s32, 55296
  s_nop 0
  buffer_load_dwordx4 v9, s[40:43], s48 offen lds
  s_add_u32 m0, s32, 58368
  s_nop 0
  buffer_load_dwordx4 v10, s[40:43], s48 offen lds
  s_add_u32 m0, s32, 61440
  s_nop 0
  buffer_load_dwordx4 v11, s[40:43], s48 offen lds
  s_add_u32 m0, s32, 64512
  s_nop 0
  buffer_load_dwordx4 v9, s[40:43], s54 offen lds
  s_add_u32 m0, s32, 67584
  s_nop 0
  buffer_load_dwordx4 v10, s[40:43], s54 offen lds
  s_add_u32 m0, s32, 70656
  s_nop 0
  buffer_load_dwordx4 v11, s[40:43], s54 offen lds
  s_waitcnt vmcnt(6)
  s_waitcnt vmcnt(0)
  s_mov_b64 exec, 1
  ds_add_u32 v20, v21 offset:68
  s_mov_b64 exec, -1
  s_mov_b32 s61, 3200000
L_sp3:
  ds_read_b32 v24, v20 offset:4
  s_sub_u32 s61, s61, 1
  s_waitcnt lgkmcnt(0)
  v_readfirstlane_b32 s60, v24
  s_cmp_eq_u32 s61, 0
  s_cbranch_scc1 L_spd4
  s_cmp_ge_u32 s60, 4
  s_cbranch_scc0 L_sp3
L_spd4:
  s_add_u32 s52, s20, 1
  s_and_b32 s52, s52, 3
  s_mul_i32 s52, s52, 9
  s_add_u32 s52, s52, 5
  s_lshr_b32 s52, s52, 1
  s_mul_i32 s48, s52, 36864
  s_add_u32 s48, s48, s49
  s_add_u32 s52, s20, 2
  s_and_b32 s52, s52, 3
  s_mul_i32 s52, s52, 9
  s_add_u32 s52, s52, 3
  s_lshr_b32 s52, s52, 1
  s_mul_i32 s54, s52, 36864
  s_add_u32 s54, s54, s49
  s_add_u32 m0, s32, 73728
  s_nop 0
  buffer_load_dwordx4 v9, s[40:43], s48 offen lds
  s_add_u32 m0, s32, 76800
  s_nop 0
  buffer_load_dwordx4 v10, s[40:43], s48 offen lds
  s_add_u32 m0, s32, 79872
  s_nop 0
  buffer_load_dwordx4 v11, s[40:43], s48 offen lds
  s_add_u32 m0, s32, 82944
  s_nop 0
  buffer_load_dwordx4 v9, s[40:43], s54 offen lds
  s_add_u32 m0, s32, 86016
  s_nop 0
  buffer_load_dwordx4 v10, s[40:43], s54 offen lds
  s_add_u32 m0, s32, 89088
  s_nop 0
  buffer_load_dwordx4 v11, s[40:43], s54 offen lds
  s_waitcnt vmcnt(6)
  s_add_u32 s52, s20, 2
  s_and_b32 s52, s52, 3
  s_mul_i32 s52, s52, 9
  s_add_u32 s52, s52, 5
  s_lshr_b32 s52, s52, 1
  s_mul_i32 s48, s52, 36864
  s_add_u32 s48, s48, s49
  s_add_u32 s52, s20, 3
  s_and_b32 s52, s52, 3
  s_mul_i32 s52, s52, 9
  s_add_u32 s52, s52, 3
  s_lshr_b32 s52, s52, 1
  s_mul_i32 s54, s52, 36864
  s_add_u32 s54, s54, s49
  s_add_u32 m0, s32, 92160
  s_nop 0
  buffer_load_dwordx4 v9, s[40:43], s48 offen lds
  s_add_u32 m0, s32, 95232
  s_nop 0
  buffer_load_dwordx4 v10, s[40:43], s48 offen lds
  s_add_u32 m0, s32, 98304
  s_nop 0
  buffer_load_dwordx4 v11, s[40:43], s48 offen lds
  s_add_u32 m0, s32, 101376
  s_nop 0
  buffer_load_dwordx4 v9, s[40:43], s54 offen lds
  s_add_u32 m0, s32, 104448
  s_nop 0
  buffer_load_dwordx4 v10, s[40:43], s54 offen lds
  s_add_u32 m0, s32, 107520
  s_nop 0
  buffer_load_dwordx4 v11, s[40:43], s54 offen lds
  s_waitcnt vmcnt(6)
  s_add_u32 s52, s20, 3
  s_and_b32 s52, s52, 3
  s_mul_i32 s52, s52, 9
  s_add_u32 s52, s52, 5
  s_lshr_b32 s52, s52, 1
  s_mul_i32 s48, s52, 36864
  s_add_u32 s48, s48, s49
  s_add_u32 s52, s20, 1
  s_and_b32 s52, s52, 3
  s_mul_i32 s52, s52, 9
  s_add_u32 s52, s52, 7
  s_lshr_b32 s52, s52, 1
  s_mul_i32 s54, s52, 36864
  s_add_u32 s54, s54, s49
  s_add_u32 m0, s32, 110592
  s_nop 0
  buffer_load_dwordx4 v9, s[40:43], s48 offen lds
  s_add_u32 m0, s32, 113664
  s_nop 0
  buffer_load_dwordx4 v10, s[40:43], s48 offen lds
  s_add_u32 m0, s32, 116736
  s_nop 0
  buffer_load_dwordx4 v11, s[40:43], s48 offen lds
  s_add_u32 m0, s32, 119808
  s_nop 0
  buffer_load_dwordx4 v9, s[40:43], s54 offen lds
  s_add_u32 m0, s32, 122880
  s_nop 0
  buffer_load_dwordx4 v10, s[40:43], s54 offen lds
  s_add_u32 m0, s32, 125952
  s_nop 0
  buffer_load_dwordx4 v11, s[40:43], s54 offen lds
  s_waitcnt vmcnt(6)
  s_mov_b64 exec, 1
  ds_add_u32 v20, v21 offset:72
  s_mov_b64 exec, -1
  s_add_u32 s52, s20, 2
  s_and_b32 s52, s52, 3
  s_mul_i32 s52, s52, 9
  s_add_u32 s52, s52, 7
  s_lshr_b32 s52, s52, 1
  s_mul_i32 s48, s52, 36864
  s_add_u32 s48, s48, s49
  s_add_u32 s52, s20, 3
  s_and_b32 s52, s52, 3
  s_mul_i32 s52, s52, 9
  s_add_u32 s52, s52, 7
  s_lshr_b32 s52, s52, 1
  s_mul_i32 s54, s52, 36864
  s_add_u32 s54, s54, s49
  s_add_u32 m0, s32, 129024
  s_nop 0
  buffer_load_dwordx4 v9, s[40:43], s48 offen lds
  s_add_u32 m0, s32, 132096
  s_nop 0
  buffer_load_dwordx4 v10, s[40:43], s48 offen lds
  s_add_u32 m0, s32, 135168
  s_nop 0
  buffer_load_dwordx4 v11, s[40:43], s48 offen lds
  s_add_u32 m0, s32, 138240
  s_nop 0
  buffer_load_dwordx4 v9, s[40:43], s54 offen lds
  s_add_u32 m0, s32, 141312
  s_nop 0
  buffer_load_dwordx4 v10, s[40:43], s54 offen lds
  s_add_u32 m0, s32, 144384
  s_nop 0
  buffer_load_dwordx4 v11, s[40:43], s54 offen lds
  s_waitcnt vmcnt(6)
  s_waitcnt vmcnt(0)
  s_mov_b64 exec, 1
  ds_add_u32 v20, v21 offset:76
  s_mov_b64 exec, -1
  s_mov_b32 s61, 3200000
L_sp5:
  ds_read_b32 v24, v20 offset:8
  s_sub_u32 s61, s61, 1
  s_waitcnt lgkmcnt(0)
  v_readfirstlane_b32 s60, v24
  s_cmp_eq_u32 s61, 0
  s_cbranch_scc1 L_spd6
  s_cmp_ge_u32 s60, 4
  s_cbranch_scc0 L_sp5
L_spd6:
  s_add_u32 s52, s20, 0
  s_and_b32 s52, s52, 3
  s_lshr_b32 s50, s52, 1
  s_mul_i32 s50, s50, 288
  s_and_b32 s52, s52, 1
  s_lshl_b32 s52, s52, 4
  s_add_u32 s50, s50, s52
  s_add_u32 s50, s50, 128
  s_add_u32 s52, s20, 1
  s_and_b32 s52, s52, 3
  s_lshr_b32 s51, s52, 1
  s_mul_i32 s51, s51, 288
  s_and_b32 s52, s52, 1
  s_lshl_b32 s52, s52, 4
  s_add_u32 s51, s51, s52
  s_add_u32 s51, s51, 128
  s_sub_u32 s51, s51, 16
  s_mul_i32 s50, s50, 1152
  s_mul_i32 s51, s51, 1152
  v_mov_b32 v33, s50
  v_mov_b32 v34, s51
  v_cmp_lt_u32 vcc, 15, v12
  s_nop 1
  v_cndmask_b32 v35, v33, v34, vcc
  v_add_u32 v27, v35, v9
  v_cmp_lt_u32 vcc, 15, v14
  s_nop 1
  v_cndmask_b32 v35, v33, v34, vcc
  v_add_u32 v28, v35, v10
  v_cmp_lt_u32 vcc, 15, v16
  s_nop 1
  v_cndmask_b32 v35, v33, v34, vcc
  v_add_u32 v29, v35, v11
  s_mov_b32 s48, s49
  s_add_u32 s52, s20, 2
  s_and_b32 s52, s52, 3
  s_lshr_b32 s50, s52, 1
  s_mul_i32 s50, s50, 288
  s_and_b32 s52, s52, 1
  s_lshl_b32 s52, s52, 4
  s_add_u32 s50, s50, s52
  s_add_u32 s50, s50, 128
  s_add_u32 s52, s20, 3
  s_and_b32 s52, s52, 3
  s_lshr_b32 s51, s52, 1
  s_mul_i32 s51, s51, 288
  s_and_b32 s52, s52, 1
  s_lshl_b32 s52, s52, 4
  s_add_u32 s51, s51, s52
  s_add_u32 s51, s51, 128
  s_sub_u32 s51, s51, 16
  s_mul_i32 s50, s50, 1152
  s_mul_i32 s51, s51, 1152
  v_mov_b32 v33, s50
  v_mov_b32 v34, s51
  v_cmp_lt_u32 vcc, 15, v12
  s_nop 1
  v_cndmask_b32 v35, v33, v34, vcc
  v_add_u32 v30, v35, v9
  v_cmp_lt_u32 vcc, 15, v14
  s_nop 1
  v_cndmask_b32 v35, v33, v34, vcc
  v_add_u32 v31, v35, v10
  v_cmp_lt_u32 vcc, 15, v16
  s_nop 1
  v_cndmask_b32 v35, v33, v34, vcc
  v_add_u32 v32, v35, v11
  s_mov_b32 s54, s49
  s_add_u32 m0, s32, 147456
  s_nop 0
  buffer_load_dwordx4 v27, s[40:43], s48 offen lds
  s_add_u32 m0, s32, 150528
  s_nop 0
  buffer_load_dwordx4 v28, s[40:43], s48 offen lds
  s_add_u32 m0, s32, 153600
  s_nop 0
  buffer_load_dwordx4 v29, s[40:43], s48 offen lds
  s_add_u32 m0, s32, 0
  s_nop 0
  buffer_load_dwordx4 v30, s[40:43], s54 offen lds
  s_add_u32 m0, s32, 3072
  s_nop 0
  buffer_load_dwordx4 v31, s[40:43], s54 offen lds
  s_add_u32 m0, s32, 6144
  s_nop 0
  buffer_load_dwordx4 v32, s[40:43], s54 offen lds
  s_waitcnt vmcnt(0)
  s_mov_b64 exec, 1
  ds_add_u32 v20, v21 offset:80
  s_mov_b64 exec, -1
L_reduce:
  s_mov_b32 s24, s12
  s_mov_b32 s25, s13
  s_mov_b32 s26, 1179648
  s_mov_b32 s27, 0x00020000
  s_mov_b32 s28, s16
  s_mov_b32 s29, s17
  s_mov_b32 s30, 33816576
  s_mov_b32 s31, 0x00020000
  s_and_b32 s45, s19, 1
  s_lshl_b32 s44, s45, 1
  s_add_u32 s44, s44, s34
  s_add_u32 s46, s45, 4
  s_cmp_eq_u32 s34, 2
  s_cselect_b32 s44, s46, s44
  s_add_u32 s46, s44, 3
  s_cmp_eq_u32 s34, 3
  s_cselect_b32 s44, s46, s44
  s_mul_i32 s44, s44, 1048576
  s_lshr_b32 s45, s19, 1
  s_lshl_b32 s45, s45, 8
  s_andn2_b32 s46, s2, 7
  s_add_u32 s45, s45, s46
  s_lshl_b32 s45, s45, 10
  s_add_u32 s44, s44, s45
  s_add_u32 s44, s44, 16777216
  v_lshlrev_b32 v5, 4, v0
  v_add_u32 v6, s44, v5
  v_add_u32 v7, 1048576, v6
  s_add_u32 s40, s19, 0
  s_and_b32 s40, s40, 7
  s_lshl_b32 s40, s40, 10
  s_add_u32 s41, s19, 1
  s_and_b32 s41, s41, 7
  s_lshl_b32 s41, s41, 10
  s_add_u32 s42, s19, 2
  s_and_b32 s42, s42, 7
  s_lshl_b32 s42, s42, 10
  s_add_u32 s43, s19, 3
  s_and_b32 s43, s43, 7
  s_lshl_b32 s43, s43, 10
  s_add_u32 s44, s19, 4
  s_and_b32 s44, s44, 7
  s_lshl_b32 s44, s44, 10
  s_add_u32 s45, s19, 5
  s_and_b32 s45, s45, 7
  s_lshl_b32 s45, s45, 10
  s_add_u32 s46, s19, 6
  s_and_b32 s46, s46, 7
  s_lshl_b32 s46, s46, 10
  s_add_u32 s47, s19, 7
  s_and_b32 s47, s47, 7
  s_lshl_b32 s47, s47, 10
  s_lshl_b32 s48, s34, 10
  s_add_u32 s48, s48, 9216
  v_add_u32 v8, s48, v5
  s_lshl_b32 s48, s21, 7
  s_lshl_b32 s49, s19, 4
  s_add_u32 s48, s48, s49
  s_mul_i32 s48, s48, 1152
  s_mul_i32 s49, s22, 288
  s_add_u32 s48, s48, s49
  s_lshl_b32 s49, s34, 6
  s_add_u32 s48, s48, s49
  v_and_b32 v1, 15, v0
  v_mul_u32_u24 v1, 1152, v1
  v_lshrrev_b32 v2, 4, v0
  v_lshl_add_u32 v1, v2, 3, v1
  s_mov_b32 s50, 0xffff0000
  v_readfirstlane_b32 s3, v23
  s_andn2_b32 s53, s2, 7
  s_lshl_b32 s53, s53, 2
  s_lshr_b32 s62, s19, 1
  s_add_u32 s53, s53, s62
  s_lshl_b32 s53, s53, 7
  s_add_u32 s53, s53, 33554432
  s_add_u32 s52, s53, 64
  s_cmp_eq_u32 s34, 3
  s_cselect_b32 s53, s52, s53
  s_max_u32 s52, s34, 1
  s_sub_u32 s52, s52, 1
  s_add_u32 s3, s3, s52
  s_add_u32 s3, s3, 4
  s_sub_u32 s62, 3, s52
  s_lshl_b32 s52, s52, 2
  v_add_u32 v26, s52, v20
  s_mov_b32 s61, 3200000
L_sp7:
  ds_read_b32 v24, v26 offset:16
  s_sub_u32 s61, s61, 1
  s_waitcnt lgkmcnt(0)
  v_readfirstlane_b32 s60, v24
  s_cmp_eq_u32 s61, 0
  s_cbranch_scc1 L_spd8
  s_cmp_ge_u32 s60, 4
  s_cbranch_scc0 L_sp7
L_spd8:
  s_mov_b32 s63, 400000
L_rprobe:
  s_sub_u32 s63, s63, 1
  s_cmp_eq_u32 s63, 0
  s_cbranch_scc1 L_fin
  s_load_dword s32, s[16:17], s53 offset:0 glc
  s_load_dword s33, s[16:17], s53 offset:512 glc
  s_load_dword s35, s[16:17], s53 offset:1024 glc
  s_load_dword s36, s[16:17], s53 offset:1536 glc
  s_load_dword s37, s[16:17], s53 offset:2048 glc
  s_load_dword s38, s[16:17], s53 offset:2560 glc
  s_load_dword s39, s[16:17], s53 offset:3072 glc
  s_load_dword s51, s[16:17], s53 offset:3584 glc
  s_waitcnt lgkmcnt(0)
  s_sub_u32 s32, s32, s3
  s_sub_u32 s33, s33, s3
  s_max_u32 s32, s32, s33
  s_sub_u32 s35, s35, s3
  s_max_u32 s32, s32, s35
  s_sub_u32 s36, s36, s3
  s_max_u32 s32, s32, s36
  s_sub_u32 s37, s37, s3
  s_max_u32 s32, s32, s37
  s_sub_u32 s38, s38, s3
  s_max_u32 s32, s32, s38
  s_sub_u32 s39, s39, s3
  s_max_u32 s32, s32, s39
  s_sub_u32 s51, s51, s3
  s_max_u32 s32, s32, s51
  s_cmp_gt_u32 s32, s62
  s_cbranch_scc1 L_rprobe
  s_cmp_eq_u32 s34, 3
  s_cbranch_scc1 L_rtag
  buffer_load_dwordx4 v[36:39], v6, s[28:31], s41 offen sc1
  buffer_load_dwordx4 v[40:43], v6, s[28:31], s42 offen sc1
  buffer_load_dwordx4 v[44:47], v6, s[28:31], s43 offen sc1
  buffer_load_dwordx4 v[48:51], v6, s[28:31], s44 offen sc1
  buffer_load_dwordx4 v[52:55], v6, s[28:31], s45 offen sc1
  buffer_load_dwordx4 v[56:59], v6, s[28:31], s46 offen sc1
  buffer_load_dwordx4 v[60:63], v6, s[28:31], s47 offen sc1
  ds_read_b128 v[32:35], v8
  s_waitcnt lgkmcnt(0)
  v_lshlrev_b32 v100, 16, v32
  v_and_b32 v101, s50, v32
  v_lshlrev_b32 v102, 16, v33
  v_and_b32 v103, s50, v33
  v_lshlrev_b32 v104, 16, v34
  v_and_b32 v105, s50, v34
  v_lshlrev_b32 v106, 16, v35
  v_and_b32 v107, s50, v35
  s_waitcnt vmcnt(6)
  v_lshlrev_b32 v116, 16, v36
  v_and_b32 v117, s50, v36
  v_lshlrev_b32 v118, 16, v37
  v_and_b32 v119, s50, v37
  v_lshlrev_b32 v120, 16, v38
  v_and_b32 v121, s50, v38
  v_lshlrev_b32 v122, 16, v39
  v_and_b32 v123, s50, v39
  v_pk_add_f32 v[100:101], v[100:101], v[116:117]
  v_pk_add_f32 v[102:103], v[102:103], v[118:119]
  v_pk_add_f32 v[104:105], v[104:105], v[120:121]
  v_pk_add_f32 v[106:107], v[106:107], v[122:123]
  s_waitcnt vmcnt(5)
  v_lshlrev_b32 v116, 16, v40
  v_and_b32 v117, s50, v40
  v_lshlrev_b32 v118, 16, v41
  v_and_b32 v119, s50, v41
  v_lshlrev_b32 v120, 16, v42
  v_and_b32 v121, s50, v42
  v_lshlrev_b32 v122, 16, v43
  v_and_b32 v123, s50, v43
  v_pk_add_f32 v[100:101], v[100:101], v[116:117]
  v_pk_add_f32 v[102:103], v[102:103], v[118:119]
  v_pk_add_f32 v[104:105], v[104:105], v[120:121]
  v_pk_add_f32 v[106:107], v[106:107], v[122:123]
  s_waitcnt vmcnt(4)
  v_lshlrev_b32 v116, 16, v44
  v_and_b32 v117, s50, v44
  v_lshlrev_b32 v118, 16, v45
  v_and_b32 v119, s50, v45
  v_lshlrev_b32 v120, 16, v46
  v_and_b32 v121, s50, v46
  v_lshlrev_b32 v122, 16, v47
  v_and_b32 v123, s50, v47
  v_pk_add_f32 v[100:101], v[100:101], v[116:117]
  v_pk_add_f32 v[102:103], v[102:103], v[118:119]
  v_pk_add_f32 v[104:105], v[104:105], v[120:121]
  v_pk_add_f32 v[106:107], v[106:107], v[122:123]
  s_waitcnt vmcnt(3)
  v_lshlrev_b32 v116, 16, v48
  v_and_b32 v117, s50, v48
  v_lshlrev_b32 v118, 16, v49
  v_and_b32 v119, s50, v49
  v_lshlrev_b32 v120, 16, v50
  v_and_b32 v121, s50, v50
  v_lshlrev_b32 v122, 16, v51
  v_and_b32 v123, s50, v51
  v_pk_add_f32 v[100:101], v[100:101], v[116:117]
  v_pk_add_f32 v[102:103], v[102:103], v[118:119]
  v_pk_add_f32 v[104:105], v[104:105], v[120:121]
  v_pk_add_f32 v[106:107], v[106:107], v[122:123]
  s_waitcnt vmcnt(2)
  v_lshlrev_b32 v116, 16, v52
  v_and_b32 v117, s50, v52
  v_lshlrev_b32 v118, 16, v53
  v_and_b32 v119, s50, v53
  v_lshlrev_b32 v120, 16, v54
  v_and_b32 v121, s50, v54
  v_lshlrev_b32 v122, 16, v55
  v_and_b32 v123, s50, v55
  v_pk_add_f32 v[100:101], v[100:101], v[116:117]
  v_pk_add_f32 v[102:103], v[102:103], v[118:119]
  v_pk_add_f32 v[104:105], v[104:105], v[120:121]
  v_pk_add_f32 v[106:107], v[106:107], v[122:123]
  s_waitcnt vmcnt(1)
  v_lshlrev_b32 v116, 16, v56
  v_and_b32 v117, s50, v56
  v_lshlrev_b32 v118, 16, v57
  v_and_b32 v119, s50, v57
  v_lshlrev_b32 v120, 16, v58
  v_and_b32 v121, s50, v58
  v_lshlrev_b32 v122, 16, v59
  v_and_b32 v123, s50, v59
  v_pk_add_f32 v[100:101], v[100:101], v[116:117]
  v_pk_add_f32 v[102:103], v[102:103], v[118:119]
  v_pk_add_f32 v[104:105], v[104:105], v[120:121]
  v_pk_add_f32 v[106:107], v[106:107], v[122:123]
  s_waitcnt vmcnt(0)
  v_lshlrev_b32 v116, 16, v60
  v_and_b32 v117, s50, v60
  v_lshlrev_b32 v118, 16, v61
  v_and_b32 v119, s50, v61
  v_lshlrev_b32 v120, 16, v62
  v_and_b32 v121, s50, v62
  v_lshlrev_b32 v122, 16, v63
  v_and_b32 v123, s50, v63
  v_pk_add_f32 v[100:101], v[100:101], v[116:117]
  v_pk_add_f32 v[102:103], v[102:103], v[118:119]
  v_pk_add_f32 v[104:105], v[104:105], v[120:121]
  v_pk_add_f32 v[106:107], v[106:107], v[122:123]
  v_cvt_pk_bf16_f32 v32, v100, v101
  v_cvt_pk_bf16_f32 v33, v102, v103
  v_cvt_pk_bf16_f32 v34, v104, v105
  v_cvt_pk_bf16_f32 v35, v106, v107
  buffer_store_dwordx2 v[32:33], v1, s[24:27], s48 offen offset:0
  buffer_store_dwordx2 v[34:35], v1, s[24:27], s48 offen offset:32
  s_branch L_fin
L_rtag:
  buffer_load_dwordx4 v[40:43], v6, s[28:31], s41 offen sc1
  buffer_load_dwordx4 v[44:47], v7, s[28:31], s41 offen sc1
  buffer_load_dwordx4 v[48:51], v6, s[28:31], s42 offen sc1
  buffer_load_dwordx4 v[52:55], v7, s[28:31], s42 offen sc1
  buffer_load_dwordx4 v[56:59], v6, s[28:31], s43 offen sc1
  buffer_load_dwordx4 v[60:63], v7, s[28:31], s43 offen sc1
  buffer_load_dwordx4 v[64:67], v6, s[28:31], s44 offen sc1
  buffer_load_dwordx4 v[68:71], v7, s[28:31], s44 offen sc1
  buffer_load_dwordx4 v[72:75], v6, s[28:31], s45 offen sc1
  buffer_load_dwordx4 v[76:79], v7, s[28:31], s45 offen sc1
  buffer_load_dwordx4 v[80:83], v6, s[28:31], s46 offen sc1
  buffer_load_dwordx4 v[84:87], v7, s[28:31], s46 offen sc1
  buffer_load_dwordx4 v[88:91], v6, s[28:31], s47 offen sc1
  buffer_load_dwordx4 v[92:95], v7, s[28:31], s47 offen sc1
  ds_read_b128 v[32:35], v8
  ds_read_b128 v[36:39], v8 offset:1024
  s_waitcnt lgkmcnt(0)
  v_xor_b32 v35, v23, v35
  v_xor_b32 v39, v23, v39
  v_or_b32 v24, v35, v39
  v_lshlrev_b32 v100, 16, v32
  v_and_b32 v101, s50, v32
  v_lshlrev_b32 v102, 16, v33
  v_and_b32 v103, s50, v33
  v_lshlrev_b32 v104, 16, v34
  v_and_b32 v105, s50, v34
  v_lshlrev_b32 v106, 16, v36
  v_and_b32 v107, s50, v36
  v_lshlrev_b32 v108, 16, v37
  v_and_b32 v109, s50, v37
  v_lshlrev_b32 v110, 16, v38
  v_and_b32 v111, s50, v38
  s_waitcnt vmcnt(12)
  v_xor_b32 v43, v23, v43
  v_xor_b32 v47, v23, v47
  v_or3_b32 v24, v43, v47, v24
  v_lshlrev_b32 v116, 16, v40
  v_and_b32 v117, s50, v40
  v_lshlrev_b32 v118, 16, v41
  v_and_b32 v119, s50, v41
  v_lshlrev_b32 v120, 16, v42
  v_and_b32 v121, s50, v42
  v_lshlrev_b32 v122, 16, v44
  v_and_b32 v123, s50, v44
  v_lshlrev_b32 v124, 16, v45
  v_and_b32 v125, s50, v45
  v_lshlrev_b32 v126, 16, v46
  v_and_b32 v127, s50, v46
  v_pk_add_f32 v[100:101], v[100:101], v[116:117]
  v_pk_add_f32 v[102:103], v[102:103], v[118:119]
  v_pk_add_f32 v[104:105], v[104:105], v[120:121]
  v_pk_add_f32 v[106:107], v[106:107], v[122:123]
  v_pk_add_f32 v[108:109], v[108:109], v[124:125]
  v_pk_add_f32 v[110:111], v[110:111], v[126:127]
  s_waitcnt vmcnt(10)
  v_xor_b32 v51, v23, v51
  v_xor_b32 v55, v23, v55
  v_or3_b32 v24, v51, v55, v24
  v_lshlrev_b32 v116, 16, v48
  v_and_b32 v117, s50, v48
  v_lshlrev_b32 v118, 16, v49
  v_and_b32 v119, s50, v49
  v_lshlrev_b32 v120, 16, v50
  v_and_b32 v121, s50, v50
  v_lshlrev_b32 v122, 16, v52
  v_and_b32 v123, s50, v52
  v_lshlrev_b32 v124, 16, v53
  v_and_b32 v125, s50, v53
  v_lshlrev_b32 v126, 16, v54
  v_and_b32 v127, s50, v54
  v_pk_add_f32 v[100:101], v[100:101], v[116:117]
  v_pk_add_f32 v[102:103], v[102:103], v[118:119]
  v_pk_add_f32 v[104:105], v[104:105], v[120:121]
  v_pk_add_f32 v[106:107], v[106:107], v[122:123]
  v_pk_add_f32 v[108:109], v[108:109], v[124:125]
  v_pk_add_f32 v[110:111], v[110:111], v[126:127]
  s_waitcnt vmcnt(8)
  v_xor_b32 v59, v23, v59
  v_xor_b32 v63, v23, v63
  v_or3_b32 v24, v59, v63, v24
  v_lshlrev_b32 v116, 16, v56
  v_and_b32 v117, s50, v56
  v_lshlrev_b32 v118, 16, v57
  v_and_b32 v119, s50, v57
  v_lshlrev_b32 v120, 16, v58
  v_and_b32 v121, s50, v58
  v_lshlrev_b32 v122, 16, v60
  v_and_b32 v123, s50, v60
  v_lshlrev_b32 v124, 16, v61
  v_and_b32 v125, s50, v61
  v_lshlrev_b32 v126, 16, v62
  v_and_b32 v127, s50, v62
  v_pk_add_f32 v[100:101], v[100:101], v[116:117]
  v_pk_add_f32 v[102:103], v[102:103], v[118:119]
  v_pk_add_f32 v[104:105], v[104:105], v[120:121]
  v_pk_add_f32 v[106:107], v[106:107], v[122:123]
  v_pk_add_f32 v[108:109], v[108:109], v[124:125]
  v_pk_add_f32 v[110:111], v[110:111], v[126:127]
  s_waitcnt vmcnt(6)
  v_xor_b32 v67, v23, v67
  v_xor_b32 v71, v23, v71
  v_or3_b32 v24, v67, v71, v24
  v_lshlrev_b32 v116, 16, v64
  v_and_b32 v117, s50, v64
  v_lshlrev_b32 v118, 16, v65
  v_and_b32 v119, s50, v65
  v_lshlrev_b32 v120, 16, v66
  v_and_b32 v121, s50, v66
  v_lshlrev_b32 v122, 16, v68
  v_and_b32 v123, s50, v68
  v_lshlrev_b32 v124, 16, v69
  v_and_b32 v125, s50, v69
  v_lshlrev_b32 v126, 16, v70
  v_and_b32 v127, s50, v70
  v_pk_add_f32 v[100:101], v[100:101], v[116:117]
  v_pk_add_f32 v[102:103], v[102:103], v[118:119]
  v_pk_add_f32 v[104:105], v[104:105], v[120:121]
  v_pk_add_f32 v[106:107], v[106:107], v[122:123]
  v_pk_add_f32 v[108:109], v[108:109], v[124:125]
  v_pk_add_f32 v[110:111], v[110:111], v[126:127]
  s_waitcnt vmcnt(4)
  v_xor_b32 v75, v23, v75
  v_xor_b32 v79, v23, v79
  v_or3_b32 v24, v75, v79, v24
  v_lshlrev_b32 v116, 16, v72
  v_and_b32 v117, s50, v72
  v_lshlrev_b32 v118, 16, v73
  v_and_b32 v119, s50, v73
  v_lshlrev_b32 v120, 16, v74
  v_and_b32 v121, s50, v74
  v_lshlrev_b32 v122, 16, v76
  v_and_b32 v123, s50, v76
  v_lshlrev_b32 v124, 16, v77
  v_and_b32 v125, s50, v77
  v_lshlrev_b32 v126, 16, v78
  v_and_b32 v127, s50, v78
  v_pk_add_f32 v[100:101], v[100:101], v[116:117]
  v_pk_add_f32 v[102:103], v[102:103], v[118:119]
  v_pk_add_f32 v[104:105], v[104:105], v[120:121]
  v_pk_add_f32 v[106:107], v[106:107], v[122:123]
  v_pk_add_f32 v[108:109], v[108:109], v[124:125]
  v_pk_add_f32 v[110:111], v[110:111], v[126:127]
  s_waitcnt vmcnt(2)
  v_xor_b32 v83, v23, v83
  v_xor_b32 v87, v23, v87
  v_or3_b32 v24, v83, v87, v24
  v_lshlrev_b32 v116, 16, v80
  v_and_b32 v117, s50, v80
  v_lshlrev_b32 v118, 16, v81
  v_and_b32 v119, s50, v81
  v_lshlrev_b32 v120, 16, v82
  v_and_b32 v121, s50, v82
  v_lshlrev_b32 v122, 16, v84
  v_and_b32 v123, s50, v84
  v_lshlrev_b32 v124, 16, v85
  v_and_b32 v125, s50, v85
  v_lshlrev_b32 v126, 16, v86
  v_and_b32 v127, s50, v86
  v_pk_add_f32 v[100:101], v[100:101], v[116:117]
  v_pk_add_f32 v[102:103], v[102:103], v[118:119]
  v_pk_add_f32 v[104:105], v[104:105], v[120:121]
  v_pk_add_f32 v[106:107], v[106:107], v[122:123]
  v_pk_add_f32 v[108:109], v[108:109], v[124:125]
  v_pk_add_f32 v[110:111], v[110:111], v[126:127]
  s_waitcnt vmcnt(0)
  v_xor_b32 v91, v23, v91
  v_xor_b32 v95, v23, v95
  v_or3_b32 v24, v91, v95, v24
  v_lshlrev_b32 v116, 16, v88
  v_and_b32 v117, s50, v88
  v_lshlrev_b32 v118, 16, v89
  v_and_b32 v119, s50, v89
  v_lshlrev_b32 v120, 16, v90
  v_and_b32 v121, s50, v90
  v_lshlrev_b32 v122, 16, v92
  v_and_b32 v123, s50, v92
  v_lshlrev_b32 v124, 16, v93
  v_and_b32 v125, s50, v93
  v_lshlrev_b32 v126, 16, v94
  v_and_b32 v127, s50, v94
  v_pk_add_f32 v[100:101], v[100:101], v[116:117]
  v_pk_add_f32 v[102:103], v[102:103], v[118:119]
  v_pk_add_f32 v[104:105], v[104:105], v[120:121]
  v_pk_add_f32 v[106:107], v[106:107], v[122:123]
  v_pk_add_f32 v[108:109], v[108:109], v[124:125]
  v_pk_add_f32 v[110:111], v[110:111], v[126:127]
  v_cmp_ne_u32 vcc, 0, v24
  v_cvt_pk_bf16_f32 v32, v100, v101
  v_cvt_pk_bf16_f32 v33, v102, v103
  v_cvt_pk_bf16_f32 v34, v104, v105
  v_cvt_pk_bf16_f32 v35, v106, v107
  v_cvt_pk_bf16_f32 v36, v108, v109
  v_cvt_pk_bf16_f32 v37, v110, v111
  s_cbranch_vccnz L_rprobe
  buffer_store_dwordx2 v[32:33], v1, s[24:27], s48 offen offset:0
  buffer_store_dwordx2 v[34:35], v1, s[24:27], s48 offen offset:32
  buffer_store_dwordx2 v[36:37], v1, s[24:27], s48 offen offset:64
  s_branch L_fin
L_poller:
  s_mov_b32 s60, 400000
  s_waitcnt vmcnt(1)
L_npoll:
  v_readfirstlane_b32 s3, v23
  s_cmp_lg_u32 s3, 0
  s_cbranch_scc1 L_nok
  s_sub_u32 s60, s60, 1
  s_cmp_eq_u32 s60, 0
  s_cbranch_scc1 L_nok
  buffer_load_dword v23, v22, s[28:31], 0 offen sc1
  s_waitcnt vmcnt(0)
  s_branch L_npoll
L_nok:
  ds_write_b32 v20, v23
  s_waitcnt lgkmcnt(0)
  s_barrier
  s_add_u32 s52, s20, 1
  s_and_b32 s52, s52, 3
  s_lshl_b32 s52, s52, 3
  s_lshl_b32 s53, s21, 5
  s_add_u32 s53, s53, s19
  s_add_u32 s53, s53, s52
  s_lshl_b32 s53, s53, 9
  s_add_u32 s25, s53, 33554432
  s_add_u32 s52, s20, 2
  s_and_b32 s52, s52, 3
  s_lshl_b32 s52, s52, 3
  s_lshl_b32 s53, s21, 5
  s_add_u32 s53, s53, s19
  s_add_u32 s53, s53, s52
  s_lshl_b32 s53, s53, 9
  s_add_u32 s26, s53, 33554432
  s_add_u32 s52, s20, 3
  s_and_b32 s52, s52, 3
  s_lshl_b32 s52, s52, 3
  s_lshl_b32 s53, s21, 5
  s_add_u32 s53, s53, s19
  s_add_u32 s53, s53, s52
  s_lshl_b32 s53, s53, 9
  s_add_u32 s27, s53, 33554432
  s_mov_b32 s61, 3200000
L_sp9:
  ds_read_b32 v24, v20 offset:12
  s_sub_u32 s61, s61, 1
  s_waitcnt lgkmcnt(0)
  v_readfirstlane_b32 s60, v24
  s_cmp_eq_u32 s61, 0
  s_cbranch_scc1 L_spd10
  s_cmp_ge_u32 s60, 1
  s_cbranch_scc0 L_sp9
L_spd10:
  s_mov_b32 s60, 400000
  s_mov_b32 s36, 0
  s_mov_b32 s37, 0
  s_mov_b32 s38, 0
  s_mov_b32 s39, 0
  s_mov_b32 s40, 0
  s_mov_b32 s41, 0
  s_mov_b32 s42, 0
  s_mov_b32 s43, 0
  s_mov_b32 s44, 0
  s_mov_b32 s45, 0
  s_mov_b32 s46, 0
  s_mov_b32 s47, 0
  s_mov_b32 s48, 0
  s_mov_b32 s49, 0
  s_mov_b32 s50, 0
  s_mov_b32 s51, 0
L_hpoll:
  s_load_dword s36, s[16:17], s25 offset:0 glc
  s_load_dword s37, s[16:17], s26 offset:0 glc
  s_load_dword s38, s[16:17], s27 offset:0 glc
  s_load_dword s39, s[16:17], s25 offset:128 glc
  s_load_dword s40, s[16:17], s26 offset:128 glc
  s_load_dword s41, s[16:17], s27 offset:128 glc
  s_load_dword s42, s[16:17], s25 offset:256 glc
  s_load_dword s43, s[16:17], s26 offset:256 glc
  s_load_dword s44, s[16:17], s27 offset:256 glc
  s_load_dword s45, s[16:17], s25 offset:384 glc
  s_load_dword s46, s[16:17], s26 offset:384 glc
  s_load_dword s47, s[16:17], s27 offset:384 glc
  s_waitcnt lgkmcnt(0)
  s_sub_u32 s32, s36, s3
  s_cmp_gt_u32 s32, 7
  s_cselect_b32 s32, 0, s32
  s_sub_u32 s33, s37, s3
  s_cmp_gt_u32 s33, 7
  s_cselect_b32 s33, 0, s33
  s_min_u32 s32, s32, s33
  s_sub_u32 s33, s38, s3
  s_cmp_gt_u32 s33, 7
  s_cselect_b32 s33, 0, s33
  s_min_u32 s32, s32, s33
  s_max_u32 s48, s48, s32
  v_mov_b32 v28, s48
  s_sub_u32 s32, s39, s3
  s_cmp_gt_u32 s32, 7
  s_cselect_b32 s32, 0, s32
  s_sub_u32 s33, s40, s3
  s_cmp_gt_u32 s33, 7
  s_cselect_b32 s33, 0, s33
  s_min_u32 s32, s32, s33
  s_sub_u32 s33, s41, s3
  s_cmp_gt_u32 s33, 7
  s_cselect_b32 s33, 0, s33
  s_min_u32 s32, s32, s33
  s_max_u32 s49, s49, s32
  v_mov_b32 v29, s49
  s_sub_u32 s32, s42, s3
  s_cmp_gt_u32 s32, 7
  s_cselect_b32 s32, 0, s32
  s_sub_u32 s33, s43, s3
  s_cmp_gt_u32 s33, 7
  s_cselect_b32 s33, 0, s33
  s_min_u32 s32, s32, s33
  s_sub_u32 s33, s44, s3
  s_cmp_gt_u32 s33, 7
  s_cselect_b32 s33, 0, s33
  s_min_u32 s32, s32, s33
  s_max_u32 s50, s50, s32
  v_mov_b32 v30, s50
  s_sub_u32 s32, s45, s3
  s_cmp_gt_u32 s32, 7
  s_cselect_b32 s32, 0, s32
  s_sub_u32 s33, s46, s3
  s_cmp_gt_u32 s33, 7
  s_cselect_b32 s33, 0, s33
  s_min_u32 s32, s32, s33
  s_sub_u32 s33, s47, s3
  s_cmp_gt_u32 s33, 7
  s_cselect_b32 s33, 0, s33
  s_min_u32 s32, s32, s33
  s_max_u32 s51, s51, s32
  v_mov_b32 v31, s51
  ds_write_b128 v20, v[28:31] offset:32
  s_min_u32 s35, s48, s49
  s_min_u32 s32, s50, s51
  s_min_u32 s35, s35, s32
  s_sub_u32 s60, s60, 1
  s_cmp_eq_u32 s60, 0
  s_cbranch_scc1 L_hdone
  s_cmp_ge_u32 s35, 3
  s_cbranch_scc0 L_hpoll
L_hdone:
  s_waitcnt lgkmcnt(0)
  s_branch L_reduce
L_compute:
  v_mov_b32 v1, 159744
  v_and_b32 v10, 31, v0
  v_lshl_add_u32 v11, v10, 2, v1
  v_mov_b32 v105, 0
  ds_write_b32 v11, v105
  v_lshrrev_b32 v10, 5, v0
  v_lshlrev_b32 v10, 4, v10
  v_bfe_u32 v11, v0, 2, 3
  v_add_u32 v10, v10, v11
  v_mul_u32_u24 v10, 288, v10
  v_and_b32 v11, 3, v0
  v_lshl_add_u32 v2, v11, 3, v10
  v_lshrrev_b32 v10, 2, v0
  v_mul_u32_u24 v10, 288, v10
  v_lshl_add_u32 v6, v11, 3, v10
  v_add_u32 v7, 55296, v6
  v_add_u32 v8, 110592, v6
  s_lshl_b32 s40, s18, 12
  s_add_u32 s40, s40, 110592
  v_and_b32 v10, 15, v0
  v_lshrrev_b32 v11, 1, v10
  v_lshrrev_b32 v13, 4, v0
  v_xor_b32 v11, v11, v13
  v_lshlrev_b32 v11, 4, v11
  v_lshl_add_u32 v10, v10, 7, v11
  v_add_u32 v3, s40, v10
  v_xor_b32 v10, 64, v10
  v_add_u32 v4, s40, v10
  v_lshlrev_b32 v5, 4, v0
  v_mov_b32 v10, 1
  v_mov_b32 v112, 0
  v_mov_b32 v113, 0
  v_mov_b32 v114, 0
  v_mov_b32 v115, 0
  v_mov_b32 v116, 0
  v_mov_b32 v117, 0
  v_mov_b32 v118, 0
  v_mov_b32 v119, 0
  v_mov_b32 v120, 0
  v_mov_b32 v121, 0
  v_mov_b32 v122, 0
  v_mov_b32 v123, 0
  v_mov_b32 v124, 0
  v_mov_b32 v125, 0
  v_mov_b32 v126, 0
  v_mov_b32 v127, 0
  v_mov_b32 v128, 0
  v_mov_b32 v129, 0
  v_mov_b32 v130, 0
  v_mov_b32 v131, 0
  v_mov_b32 v132, 0
  v_mov_b32 v133, 0
  v_mov_b32 v134, 0
  v_mov_b32 v135, 0
  v_mov_b32 v136, 0
  v_mov_b32 v137, 0
  v_mov_b32 v138, 0
  v_mov_b32 v139, 0
  v_mov_b32 v140, 0
  v_mov_b32 v141, 0
  v_mov_b32 v142, 0
  v_mov_b32 v143, 0
  v_mov_b32 v144, 0
  v_mov_b32 v145, 0
  v_mov_b32 v146, 0
  v_mov_b32 v147, 0
  v_mov_b32 v148, 0
  v_mov_b32 v149, 0
  v_mov_b32 v150, 0
  v_mov_b32 v151, 0
  v_mov_b32 v152, 0
  v_mov_b32 v153, 0
  v_mov_b32 v154, 0
  v_mov_b32 v155, 0
  v_mov_b32 v156, 0
  v_mov_b32 v157, 0
  v_mov_b32 v158, 0
  v_mov_b32 v159, 0
  v_mov_b32 v160, 0
  v_mov_b32 v161, 0
  v_mov_b32 v162, 0
  v_mov_b32 v163, 0
  v_mov_b32 v164, 0
  v_mov_b32 v165, 0
  v_mov_b32 v166, 0
  v_mov_b32 v167, 0
  v_mov_b32 v168, 0
  v_mov_b32 v169, 0
  v_mov_b32 v170, 0
  v_mov_b32 v171, 0
  v_mov_b32 v172, 0
  v_mov_b32 v173, 0
  v_mov_b32 v174, 0
  v_mov_b32 v175, 0
  v_mov_b32 v176, 0
  v_mov_b32 v177, 0
  v_mov_b32 v178, 0
  v_mov_b32 v179, 0
  v_mov_b32 v180, 0
  v_mov_b32 v181, 0
  v_mov_b32 v182, 0
  v_mov_b32 v183, 0
  v_mov_b32 v184, 0
  v_mov_b32 v185, 0
  v_mov_b32 v186, 0
  v_mov_b32 v187, 0
  v_mov_b32 v188, 0
  v_mov_b32 v189, 0
  v_mov_b32 v190, 0
  v_mov_b32 v191, 0
  v_mov_b32 v192, 0
  v_mov_b32 v193, 0
  v_mov_b32 v194, 0
  v_mov_b32 v195, 0
  v_mov_b32 v196, 0
  v_mov_b32 v197, 0
  v_mov_b32 v198, 0
  v_mov_b32 v199, 0
  v_mov_b32 v200, 0
  v_mov_b32 v201, 0
  v_mov_b32 v202, 0
  v_mov_b32 v203, 0
  v_mov_b32 v204, 0
  v_mov_b32 v205, 0
  v_mov_b32 v206, 0
  v_mov_b32 v207, 0
  v_mov_b32 v208, 0
  v_mov_b32 v209, 0
  v_mov_b32 v210, 0
  v_mov_b32 v211, 0
  v_mov_b32 v212, 0
  v_mov_b32 v213, 0
  v_mov_b32 v214, 0
  v_mov_b32 v215, 0
  v_mov_b32 v216, 0
  v_mov_b32 v217, 0
  v_mov_b32 v218, 0
  v_mov_b32 v219, 0
  v_mov_b32 v220, 0
  v_mov_b32 v221, 0
  v_mov_b32 v222, 0
  v_mov_b32 v223, 0
  v_mov_b32 v224, 0
  v_mov_b32 v225, 0
  v_mov_b32 v226, 0
  v_mov_b32 v227, 0
  v_mov_b32 v228, 0
  v_mov_b32 v229, 0
  v_mov_b32 v230, 0
  v_mov_b32 v231, 0
  v_mov_b32 v232, 0
  v_mov_b32 v233, 0
  v_mov_b32 v234, 0
  v_mov_b32 v235, 0
  v_mov_b32 v236, 0
  v_mov_b32 v237, 0
  v_mov_b32 v238, 0
  v_mov_b32 v239, 0
  v_mov_b32 v240, 0
  v_mov_b32 v241, 0
  v_mov_b32 v242, 0
  v_mov_b32 v243, 0
  v_mov_b32 v244, 0
  v_mov_b32 v245, 0
  v_mov_b32 v246, 0
  v_mov_b32 v247, 0
  v_mov_b32 v248, 0
  v_mov_b32 v249, 0
  v_mov_b32 v250, 0
  v_mov_b32 v251, 0
  v_mov_b32 v252, 0
  v_mov_b32 v253, 0
  v_mov_b32 v254, 0
  v_mov_b32 v255, 0
  s_mov_b32 s54, 0xbdd2d3e8
  s_mov_b32 s55, 0xbdd2d3e8
  v_mov_b32 v14, 0xc0135761
  v_mov_b32 v15, 0xc0135761
  s_mov_b32 s24, 0
  s_mov_b32 s25, 1048576
  s_mov_b32 s26, 2097152
  s_mov_b32 s27, 3145728
  s_mov_b32 s32, 4194304
  s_mov_b32 s33, 5242880
  s_mov_b32 s34, 6291456
  s_mov_b32 s35, 7340032
  s_mov_b32 s36, 8388608
  s_mov_b32 s37, 9437184
  s_mov_b32 s38, 10485760
  s_mov_b32 s39, 11534336
  s_lshl_b32 s40, s21, 5
  s_add_u32 s40, s40, s19
  s_lshl_b32 s41, s18, 8
  s_add_u32 s40, s40, s41
  s_add_u32 s41, s20, 3
  s_and_b32 s41, s41, 3
  s_lshl_b32 s41, s41, 3
  s_add_u32 s41, s41, s40
  s_lshl_b32 s41, s41, 10
  v_add_u32 v13, s41, v5
  s_add_u32 s41, s20, 2
  s_and_b32 s41, s41, 3
  s_lshl_b32 s41, s41, 3
  s_add_u32 s41, s41, s40
  s_lshl_b32 s41, s41, 10
  v_add_u32 v12, s41, v5
  s_add_u32 s41, s20, 1
  s_and_b32 s41, s41, 3
  s_lshl_b32 s41, s41, 3
  s_add_u32 s41, s41, s40
  s_lshl_b32 s41, s41, 10
  v_add_u32 v9, s41, v5
  s_add_u32 s41, s20, 0
  s_and_b32 s41, s41, 3
  s_lshl_b32 s41, s41, 3
  s_add_u32 s41, s41, s40
  s_lshl_b32 s41, s41, 10
  v_add_u32 v5, s41, v5
  s_lshl_b32 s43, s2, 2
  s_add_u32 s43, s43, s18
  s_lshl_b32 s43, s43, 7
  s_add_u32 s43, s43, 33554432
  s_lshl_b32 s40, s18, 2
  v_add_u32 v106, s40, v1
  s_waitcnt lgkmcnt(0)
  s_mov_b32 s28, s16
  s_mov_b32 s29, s17
  s_mov_b32 s30, 33816576
  s_mov_b32 s31, 0x00020000
  s_add_u32 s44, s16, 16777216
  s_addc_u32 s45, s17, 0
  s_mov_b32 s46, 16777216
  s_mov_b32 s47, 0x00020000
  s_lshr_b32 s62, s2, 3
  s_lshl_b32 s62, s62, 2
  s_add_u32 s62, s62, s18
  s_getpc_b64 s[60:61]
L_pc:
  s_sub_u32 s60, s60, L_pc-standalone__geglu_ffn__sampling_kernel
  s_subb_u32 s61, s61, 0
  s_lshl_b32 s53, s62, 6
  s_load_dword s63, s[60:61], s53
  s_load_dword s63, s[60:61], s53 offset:8192
  s_add_u32 s53, s53, 16384
  s_min_u32 s53, s53, L_codeend-standalone__geglu_ffn__sampling_kernel-4
  s_load_dword s63, s[60:61], s53
  s_or_b32 s53, s2, s18
  s_cmp_eq_u32 s53, 0
  s_cbranch_scc0 L_nononce
  s_mov_b32 s56, s14
  s_mov_b32 s57, s15
  s_mov_b32 s58, 256
  s_mov_b32 s59, 0x00020000
  s_memrealtime s[96:97]
  s_waitcnt lgkmcnt(0)
  s_lshl_b32 s53, s96, 3
  s_max_u32 s53, s53, 8
  v_mov_b32 v104, s53
  buffer_store_dword v104, v105, s[56:59], 0 offen sc1
L_nononce:
  s_mov_b64 exec, 1
  buffer_store_dword v105, v105, s[28:31], s43 offen sc1
  s_mov_b64 exec, -1
  s_barrier
  ds_read_b128 v[40:43], v3 offset:0
  ds_read_b128 v[44:47], v3 offset:2048
  ds_read_b64_tr_b16 v[16:17], v2 offset:0
  ds_read_b64_tr_b16 v[18:19], v2 offset:2304
  ds_read_b64_tr_b16 v[20:21], v2 offset:9216
  ds_read_b64_tr_b16 v[22:23], v2 offset:11520
  ds_read_b64_tr_b16 v[24:25], v2 offset:32
  ds_read_b64_tr_b16 v[26:27], v2 offset:2336
  ds_read_b64_tr_b16 v[28:29], v2 offset:9248
  ds_read_b64_tr_b16 v[30:31], v2 offset:11552
  ds_read_b64_tr_b16 v[32:33], v2 offset:64
  ds_read_b64_tr_b16 v[34:35], v2 offset:2368
  s_mov_b32 s48, 9
  s_mov_b32 s51, 0
L_loop:
  s_add_u32 s51, s51, 1
  s_cmp_eq_u32 s51, 3
  s_mov_b32 s52, 36864
  s_cmov_b32 s52, 4294893568
  s_mov_b32 s53, 16384
  s_cmov_b32 s53, 4294934528
  s_cselect_b32 s51, 0, s51
  s_waitcnt lgkmcnt(8)
  v_mfma_f32_16x16x32_bf16 v[112:115], v[16:19], v[40:43], v[112:115]
  ds_read_b64_tr_b16 v[36:37], v2 offset:9280
  v_mfma_f32_16x16x32_bf16 v[128:131], v[16:19], v[44:47], v[128:131]
  ds_read_b64_tr_b16 v[38:39], v2 offset:11584
  s_waitcnt lgkmcnt(8)
  v_mfma_f32_16x16x32_bf16 v[116:119], v[20:23], v[40:43], v[116:119]
  ds_read_b64_tr_b16 v[16:17], v2 offset:96
  v_mfma_f32_16x16x32_bf16 v[132:135], v[20:23], v[44:47], v[132:135]
  ds_read_b64_tr_b16 v[18:19], v2 offset:2400
  s_waitcnt lgkmcnt(8)
  v_mfma_f32_16x16x32_bf16 v[120:123], v[24:27], v[40:43], v[120:123]
  ds_read_b64_tr_b16 v[20:21], v2 offset:9312
  v_mfma_f32_16x16x32_bf16 v[136:139], v[24:27], v[44:47], v[136:139]
  ds_read_b64_tr_b16 v[22:23], v2 offset:11616
  s_waitcnt lgkmcnt(8)
  v_mfma_f32_16x16x32_bf16 v[124:127], v[28:31], v[40:43], v[124:127]
  ds_read_b64_tr_b16 v[24:25], v2 offset:128
  v_mfma_f32_16x16x32_bf16 v[140:143], v[28:31], v[44:47], v[140:143]
  ds_read_b64_tr_b16 v[26:27], v2 offset:2432
  s_waitcnt lgkmcnt(8)
  v_mfma_f32_16x16x32_bf16 v[144:147], v[32:35], v[40:43], v[144:147]
  ds_read_b64_tr_b16 v[28:29], v2 offset:9344
  v_mfma_f32_16x16x32_bf16 v[160:163], v[32:35], v[44:47], v[160:163]
  ds_read_b64_tr_b16 v[30:31], v2 offset:11648
  s_waitcnt lgkmcnt(8)
  v_mfma_f32_16x16x32_bf16 v[148:151], v[36:39], v[40:43], v[148:151]
  ds_read_b64_tr_b16 v[32:33], v2 offset:160
  v_mfma_f32_16x16x32_bf16 v[164:167], v[36:39], v[44:47], v[164:167]
  ds_read_b64_tr_b16 v[34:35], v2 offset:2464
  s_waitcnt lgkmcnt(8)
  v_mfma_f32_16x16x32_bf16 v[152:155], v[16:19], v[40:43], v[152:155]
  ds_read_b64_tr_b16 v[36:37], v2 offset:9376
  v_mfma_f32_16x16x32_bf16 v[168:171], v[16:19], v[44:47], v[168:171]
  ds_read_b64_tr_b16 v[38:39], v2 offset:11680
  s_waitcnt lgkmcnt(8)
  v_mfma_f32_16x16x32_bf16 v[156:159], v[20:23], v[40:43], v[156:159]
  ds_read_b64_tr_b16 v[16:17], v2 offset:192
  v_mfma_f32_16x16x32_bf16 v[172:175], v[20:23], v[44:47], v[172:175]
  ds_read_b64_tr_b16 v[18:19], v2 offset:2496
  s_waitcnt lgkmcnt(8)
  v_mfma_f32_16x16x32_bf16 v[176:179], v[24:27], v[40:43], v[176:179]
  ds_read_b64_tr_b16 v[20:21], v2 offset:9408
  v_mfma_f32_16x16x32_bf16 v[192:195], v[24:27], v[44:47], v[192:195]
  ds_read_b64_tr_b16 v[22:23], v2 offset:11712
  s_waitcnt lgkmcnt(8)
  v_mfma_f32_16x16x32_bf16 v[180:183], v[28:31], v[40:43], v[180:183]
  ds_read_b64_tr_b16 v[24:25], v2 offset:224
  v_mfma_f32_16x16x32_bf16 v[196:199], v[28:31], v[44:47], v[196:199]
  ds_read_b64_tr_b16 v[26:27], v2 offset:2528
  s_waitcnt lgkmcnt(8)
  v_mfma_f32_16x16x32_bf16 v[184:187], v[32:35], v[40:43], v[184:187]
  ds_read_b64_tr_b16 v[28:29], v2 offset:9440
  v_mfma_f32_16x16x32_bf16 v[200:203], v[32:35], v[44:47], v[200:203]
  ds_read_b64_tr_b16 v[30:31], v2 offset:11744
  s_waitcnt lgkmcnt(8)
  v_mfma_f32_16x16x32_bf16 v[188:191], v[36:39], v[40:43], v[188:191]
  ds_read_b64_tr_b16 v[32:33], v2 offset:256
  v_mfma_f32_16x16x32_bf16 v[204:207], v[36:39], v[44:47], v[204:207]
  ds_read_b64_tr_b16 v[34:35], v2 offset:2560
  s_waitcnt lgkmcnt(8)
  v_mfma_f32_16x16x32_bf16 v[208:211], v[16:19], v[40:43], v[208:211]
  ds_read_b64_tr_b16 v[36:37], v2 offset:9472
  v_mfma_f32_16x16x32_bf16 v[224:227], v[16:19], v[44:47], v[224:227]
  ds_read_b64_tr_b16 v[38:39], v2 offset:11776
  s_barrier
  ds_read_b128 v[48:51], v4 offset:0
  ds_read_b128 v[52:55], v4 offset:2048
  v_add_u32 v4, s53, v4
  s_waitcnt lgkmcnt(10)
  v_mfma_f32_16x16x32_bf16 v[212:215], v[20:23], v[40:43], v[212:215]
  ds_read_b64_tr_b16 v[16:17], v2 offset:18432
  v_mfma_f32_16x16x32_bf16 v[228:231], v[20:23], v[44:47], v[228:231]
  ds_read_b64_tr_b16 v[18:19], v2 offset:20736
  s_waitcnt lgkmcnt(10)
  v_mfma_f32_16x16x32_bf16 v[216:219], v[24:27], v[40:43], v[216:219]
  ds_read_b64_tr_b16 v[20:21], v2 offset:27648
  v_mfma_f32_16x16x32_bf16 v[232:235], v[24:27], v[44:47], v[232:235]
  ds_read_b64_tr_b16 v[22:23], v2 offset:29952
  s_waitcnt lgkmcnt(10)
  v_mfma_f32_16x16x32_bf16 v[220:223], v[28:31], v[40:43], v[220:223]
  ds_read_b64_tr_b16 v[24:25], v2 offset:18464
  v_mfma_f32_16x16x32_bf16 v[236:239], v[28:31], v[44:47], v[236:239]
  ds_read_b64_tr_b16 v[26:27], v2 offset:20768
  s_waitcnt lgkmcnt(10)
  v_mfma_f32_16x16x32_bf16 v[240:243], v[32:35], v[40:43], v[240:243]
  ds_read_b64_tr_b16 v[28:29], v2 offset:27680
  v_mfma_f32_16x16x32_bf16 v[248:251], v[32:35], v[44:47], v[248:251]
  ds_read_b64_tr_b16 v[30:31], v2 offset:29984
  s_waitcnt lgkmcnt(10)
  v_mfma_f32_16x16x32_bf16 v[244:247], v[36:39], v[40:43], v[244:247]
  ds_read_b64_tr_b16 v[32:33], v2 offset:18496
  v_mfma_f32_16x16x32_bf16 v[252:255], v[36:39], v[44:47], v[252:255]
  ds_read_b64_tr_b16 v[34:35], v2 offset:20800
  s_cmp_eq_u32 s48, 1
  s_cbranch_scc1 L_peel
  s_waitcnt lgkmcnt(8)
  v_mfma_f32_16x16x32_bf16 v[112:115], v[16:19], v[48:51], v[112:115]
  ds_read_b64_tr_b16 v[36:37], v2 offset:27712
  v_mfma_f32_16x16x32_bf16 v[128:131], v[16:19], v[52:55], v[128:131]
  ds_read_b64_tr_b16 v[38:39], v2 offset:30016
  s_waitcnt lgkmcnt(8)
  v_mfma_f32_16x16x32_bf16 v[116:119], v[20:23], v[48:51], v[116:119]
  ds_read_b64_tr_b16 v[16:17], v2 offset:18528
  v_mfma_f32_16x16x32_bf16 v[132:135], v[20:23], v[52:55], v[132:135]
  ds_read_b64_tr_b16 v[18:19], v2 offset:20832
  s_waitcnt lgkmcnt(8)
  v_mfma_f32_16x16x32_bf16 v[120:123], v[24:27], v[48:51], v[120:123]
  ds_read_b64_tr_b16 v[20:21], v2 offset:27744
  v_mfma_f32_16x16x32_bf16 v[136:139], v[24:27], v[52:55], v[136:139]
  ds_read_b64_tr_b16 v[22:23], v2 offset:30048
  s_waitcnt lgkmcnt(8)
  v_mfma_f32_16x16x32_bf16 v[124:127], v[28:31], v[48:51], v[124:127]
  ds_read_b64_tr_b16 v[24:25], v2 offset:18560
  v_mfma_f32_16x16x32_bf16 v[140:143], v[28:31], v[52:55], v[140:143]
  ds_read_b64_tr_b16 v[26:27], v2 offset:20864
  s_waitcnt lgkmcnt(8)
  v_mfma_f32_16x16x32_bf16 v[144:147], v[32:35], v[48:51], v[144:147]
  ds_read_b64_tr_b16 v[28:29], v2 offset:27776
  v_mfma_f32_16x16x32_bf16 v[160:163], v[32:35], v[52:55], v[160:163]
  ds_read_b64_tr_b16 v[30:31], v2 offset:30080
  s_waitcnt lgkmcnt(8)
  v_mfma_f32_16x16x32_bf16 v[148:151], v[36:39], v[48:51], v[148:151]
  ds_read_b64_tr_b16 v[32:33], v2 offset:18592
  v_mfma_f32_16x16x32_bf16 v[164:167], v[36:39], v[52:55], v[164:167]
  ds_read_b64_tr_b16 v[34:35], v2 offset:20896
  s_waitcnt lgkmcnt(8)
  v_mfma_f32_16x16x32_bf16 v[152:155], v[16:19], v[48:51], v[152:155]
  ds_read_b64_tr_b16 v[36:37], v2 offset:27808
  v_mfma_f32_16x16x32_bf16 v[168:171], v[16:19], v[52:55], v[168:171]
  ds_read_b64_tr_b16 v[38:39], v2 offset:30112
  s_waitcnt lgkmcnt(8)
  v_mfma_f32_16x16x32_bf16 v[156:159], v[20:23], v[48:51], v[156:159]
  ds_read_b64_tr_b16 v[16:17], v2 offset:18624
  v_mfma_f32_16x16x32_bf16 v[172:175], v[20:23], v[52:55], v[172:175]
  ds_read_b64_tr_b16 v[18:19], v2 offset:20928
  s_waitcnt lgkmcnt(8)
  v_mfma_f32_16x16x32_bf16 v[176:179], v[24:27], v[48:51], v[176:179]
  ds_read_b64_tr_b16 v[20:21], v2 offset:27840
  v_mfma_f32_16x16x32_bf16 v[192:195], v[24:27], v[52:55], v[192:195]
  ds_read_b64_tr_b16 v[22:23], v2 offset:30144
  s_waitcnt lgkmcnt(8)
  v_mfma_f32_16x16x32_bf16 v[180:183], v[28:31], v[48:51], v[180:183]
  ds_read_b64_tr_b16 v[24:25], v2 offset:18656
  v_mfma_f32_16x16x32_bf16 v[196:199], v[28:31], v[52:55], v[196:199]
  ds_read_b64_tr_b16 v[26:27], v2 offset:20960
  s_waitcnt lgkmcnt(8)
  v_mfma_f32_16x16x32_bf16 v[184:187], v[32:35], v[48:51], v[184:187]
  ds_read_b64_tr_b16 v[28:29], v2 offset:27872
  v_mfma_f32_16x16x32_bf16 v[200:203], v[32:35], v[52:55], v[200:203]
  ds_read_b64_tr_b16 v[30:31], v2 offset:30176
  s_waitcnt lgkmcnt(8)
  v_mfma_f32_16x16x32_bf16 v[188:191], v[36:39], v[48:51], v[188:191]
  ds_read_b64_tr_b16 v[32:33], v2 offset:18688
  v_mfma_f32_16x16x32_bf16 v[204:207], v[36:39], v[52:55], v[204:207]
  ds_read_b64_tr_b16 v[34:35], v2 offset:20992
  s_waitcnt lgkmcnt(8)
  v_mfma_f32_16x16x32_bf16 v[208:211], v[16:19], v[48:51], v[208:211]
  ds_read_b64_tr_b16 v[36:37], v2 offset:27904
  v_mfma_f32_16x16x32_bf16 v[224:227], v[16:19], v[52:55], v[224:227]
  ds_read_b64_tr_b16 v[38:39], v2 offset:30208
  s_barrier
  v_add_u32 v2, s52, v2
  v_add_u32 v3, s53, v3
  ds_read_b128 v[40:43], v3 offset:0
  ds_read_b128 v[44:47], v3 offset:2048
  s_waitcnt lgkmcnt(10)
  v_mfma_f32_16x16x32_bf16 v[212:215], v[20:23], v[48:51], v[212:215]
  ds_read_b64_tr_b16 v[16:17], v2 offset:0
  v_mfma_f32_16x16x32_bf16 v[228:231], v[20:23], v[52:55], v[228:231]
  ds_read_b64_tr_b16 v[18:19], v2 offset:2304
  s_waitcnt lgkmcnt(10)
  v_mfma_f32_16x16x32_bf16 v[216:219], v[24:27], v[48:51], v[216:219]
  ds_read_b64_tr_b16 v[20:21], v2 offset:9216
  v_mfma_f32_16x16x32_bf16 v[232:235], v[24:27], v[52:55], v[232:235]
  ds_read_b64_tr_b16 v[22:23], v2 offset:11520
  s_waitcnt lgkmcnt(10)
  v_mfma_f32_16x16x32_bf16 v[220:223], v[28:31], v[48:51], v[220:223]
  ds_read_b64_tr_b16 v[24:25], v2 offset:32
  v_mfma_f32_16x16x32_bf16 v[236:239], v[28:31], v[52:55], v[236:239]
  ds_read_b64_tr_b16 v[26:27], v2 offset:2336
  s_waitcnt lgkmcnt(10)
  v_mfma_f32_16x16x32_bf16 v[240:243], v[32:35], v[48:51], v[240:243]
  ds_read_b64_tr_b16 v[28:29], v2 offset:9248
  v_mfma_f32_16x16x32_bf16 v[248:251], v[32:35], v[52:55], v[248:251]
  ds_read_b64_tr_b16 v[30:31], v2 offset:11552
  s_waitcnt lgkmcnt(10)
  v_mfma_f32_16x16x32_bf16 v[244:247], v[36:39], v[48:51], v[244:247]
  ds_read_b64_tr_b16 v[32:33], v2 offset:64
  v_mfma_f32_16x16x32_bf16 v[252:255], v[36:39], v[52:55], v[252:255]
  ds_read_b64_tr_b16 v[34:35], v2 offset:2368
  s_sub_u32 s48, s48, 1
  s_branch L_loop
L_peel:
  ds_read_b32 v11, v1
  s_lshr_b32 s40, s19, 1
  s_and_b32 s49, s19, 1
  s_cmp_eq_u32 s40, s18
  s_cselect_b32 s49, s49, 2
  v_lshlrev_b32 v107, 4, v0
  v_add_u32 v107, 9216, v107
  s_waitcnt lgkmcnt(9)
  v_mfma_f32_16x16x32_bf16 v[112:115], v[16:19], v[48:51], v[112:115]
  ds_read_b64_tr_b16 v[36:37], v2 offset:27712
  v_mfma_f32_16x16x32_bf16 v[128:131], v[16:19], v[52:55], v[128:131]
  ds_read_b64_tr_b16 v[38:39], v2 offset:30016
  s_waitcnt lgkmcnt(9)
  v_mfma_f32_16x16x32_bf16 v[116:119], v[20:23], v[48:51], v[116:119]
  ds_read_b64_tr_b16 v[16:17], v2 offset:18528
  v_mfma_f32_16x16x32_bf16 v[132:135], v[20:23], v[52:55], v[132:135]
  ds_read_b64_tr_b16 v[18:19], v2 offset:20832
  s_waitcnt lgkmcnt(9)
  v_mfma_f32_16x16x32_bf16 v[120:123], v[24:27], v[48:51], v[120:123]
  ds_read_b64_tr_b16 v[20:21], v2 offset:27744
  v_mfma_f32_16x16x32_bf16 v[136:139], v[24:27], v[52:55], v[136:139]
  ds_read_b64_tr_b16 v[22:23], v2 offset:30048
  s_waitcnt lgkmcnt(9)
  v_mfma_f32_16x16x32_bf16 v[124:127], v[28:31], v[48:51], v[124:127]
  ds_read_b64_tr_b16 v[24:25], v2 offset:18560
  v_mfma_f32_16x16x32_bf16 v[140:143], v[28:31], v[52:55], v[140:143]
  ds_read_b64_tr_b16 v[26:27], v2 offset:20864
  s_waitcnt lgkmcnt(9)
  v_mfma_f32_16x16x32_bf16 v[144:147], v[32:35], v[48:51], v[144:147]
  ds_read_b64_tr_b16 v[28:29], v2 offset:27776
  v_mfma_f32_16x16x32_bf16 v[160:163], v[32:35], v[52:55], v[160:163]
  ds_read_b64_tr_b16 v[30:31], v2 offset:30080
  s_waitcnt lgkmcnt(8)
  v_mfma_f32_16x16x32_bf16 v[148:151], v[36:39], v[48:51], v[148:151]
  ds_read_b64_tr_b16 v[32:33], v2 offset:18592
  v_mfma_f32_16x16x32_bf16 v[164:167], v[36:39], v[52:55], v[164:167]
  ds_read_b64_tr_b16 v[34:35], v2 offset:20896
  s_waitcnt lgkmcnt(8)
  v_mfma_f32_16x16x32_bf16 v[152:155], v[16:19], v[48:51], v[152:155]
  ds_read_b64_tr_b16 v[36:37], v2 offset:27808
  v_mfma_f32_16x16x32_bf16 v[168:171], v[16:19], v[52:55], v[168:171]
  ds_read_b64_tr_b16 v[38:39], v2 offset:30112
  s_waitcnt lgkmcnt(8)
  v_mfma_f32_16x16x32_bf16 v[156:159], v[20:23], v[48:51], v[156:159]
  ds_read_b64_tr_b16 v[16:17], v2 offset:18624
  v_mfma_f32_16x16x32_bf16 v[172:175], v[20:23], v[52:55], v[172:175]
  ds_read_b64_tr_b16 v[18:19], v2 offset:20928
  v_pk_mul_f32 v[40:41], v[112:113], v[112:113]
  v_pk_mul_f32 v[42:43], v[114:115], v[114:115]
  v_pk_mul_f32 v[44:45], v[120:121], v[120:121]
  v_pk_mul_f32 v[46:47], v[122:123], v[122:123]
  v_pk_fma_f32 v[40:41], v[40:41], s[54:55], v[14:15]
  v_pk_fma_f32 v[42:43], v[42:43], s[54:55], v[14:15]
  v_pk_fma_f32 v[44:45], v[44:45], s[54:55], v[14:15]
  v_pk_fma_f32 v[46:47], v[46:47], s[54:55], v[14:15]
  v_pk_mul_f32 v[40:41], v[40:41], v[112:113]
  v_pk_mul_f32 v[42:43], v[42:43], v[114:115]
  v_pk_mul_f32 v[44:45], v[44:45], v[120:121]
  v_pk_mul_f32 v[46:47], v[46:47], v[122:123]
  v_exp_f32 v40, v40
  v_pk_mul_f32 v[112:113], v[112:113], v[116:117]
  v_exp_f32 v41, v41
  v_pk_mul_f32 v[114:115], v[114:115], v[118:119]
  v_exp_f32 v42, v42
  v_pk_mul_f32 v[120:121], v[120:121], v[124:125]
  v_exp_f32 v43, v43
  v_pk_mul_f32 v[122:123], v[122:123], v[126:127]
  v_exp_f32 v44, v44
  v_exp_f32 v45, v45
  v_exp_f32 v46, v46
  v_exp_f32 v47, v47
  v_pk_add_f32 v[40:41], v[40:41], 1.0 op_sel_hi:[1,0]
  v_pk_add_f32 v[42:43], v[42:43], 1.0 op_sel_hi:[1,0]
  v_pk_add_f32 v[44:45], v[44:45], 1.0 op_sel_hi:[1,0]
  v_pk_add_f32 v[46:47], v[46:47], 1.0 op_sel_hi:[1,0]
  v_rcp_f32 v40, v40
  v_pk_mul_f32 v[92:93], v[128:129], v[128:129]
  v_rcp_f32 v41, v41
  v_pk_mul_f32 v[94:95], v[130:131], v[130:131]
  v_pk_mul_f32 v[96:97], v[136:137], v[136:137]
  v_rcp_f32 v42, v42
  v_pk_mul_f32 v[98:99], v[138:139], v[138:139]
  v_pk_fma_f32 v[92:93], v[92:93], s[54:55], v[14:15]
  v_rcp_f32 v43, v43
  v_pk_fma_f32 v[94:95], v[94:95], s[54:55], v[14:15]
  v_pk_fma_f32 v[96:97], v[96:97], s[54:55], v[14:15]
  v_rcp_f32 v44, v44
  v_pk_fma_f32 v[98:99], v[98:99], s[54:55], v[14:15]
  v_pk_mul_f32 v[92:93], v[92:93], v[128:129]
  v_rcp_f32 v45, v45
  v_pk_mul_f32 v[94:95], v[94:95], v[130:131]
  v_rcp_f32 v46, v46
  v_pk_mul_f32 v[96:97], v[96:97], v[136:137]
  v_rcp_f32 v47, v47
  v_pk_mul_f32 v[98:99], v[98:99], v[138:139]
  v_exp_f32 v92, v92
  v_pk_mul_f32 v[112:113], v[112:113], v[40:41]
  v_pk_mul_f32 v[114:115], v[114:115], v[42:43]
  v_exp_f32 v93, v93
  v_pk_mul_f32 v[120:121], v[120:121], v[44:45]
  v_pk_mul_f32 v[122:123], v[122:123], v[46:47]
  v_exp_f32 v94, v94
  v_cvt_pk_bf16_f32 v56, v112, v113
  v_cvt_pk_bf16_f32 v57, v114, v115
  v_exp_f32 v95, v95
  v_cvt_pk_bf16_f32 v58, v120, v121
  v_cvt_pk_bf16_f32 v59, v122, v123
  v_exp_f32 v96, v96
  buffer_store_dwordx4 v[56:59], v5, s[28:31], s24 offen sc1
  v_pk_mul_f32 v[128:129], v[128:129], v[132:133]
  v_exp_f32 v97, v97
  v_pk_mul_f32 v[130:131], v[130:131], v[134:135]
  v_exp_f32 v98, v98
  v_pk_mul_f32 v[136:137], v[136:137], v[140:141]
  v_exp_f32 v99, v99
  v_pk_mul_f32 v[138:139], v[138:139], v[142:143]
  v_pk_add_f32 v[92:93], v[92:93], 1.0 op_sel_hi:[1,0]
  v_pk_add_f32 v[94:95], v[94:95], 1.0 op_sel_hi:[1,0]
  v_pk_add_f32 v[96:97], v[96:97], 1.0 op_sel_hi:[1,0]
  v_pk_add_f32 v[98:99], v[98:99], 1.0 op_sel_hi:[1,0]
  v_rcp_f32 v92, v92
  v_pk_mul_f32 v[40:41], v[144:145], v[144:145]
  v_rcp_f32 v93, v93
  v_pk_mul_f32 v[42:43], v[146:147], v[146:147]
  v_pk_mul_f32 v[44:45], v[152:153], v[152:153]
  v_rcp_f32 v94, v94
  v_pk_mul_f32 v[46:47], v[154:155], v[154:155]
  v_pk_fma_f32 v[40:41], v[40:41], s[54:55], v[14:15]
  v_rcp_f32 v95, v95
  v_pk_fma_f32 v[42:43], v[42:43], s[54:55], v[14:15]
  v_pk_fma_f32 v[44:45], v[44:45], s[54:55], v[14:15]
  v_rcp_f32 v96, v96
  v_pk_fma_f32 v[46:47], v[46:47], s[54:55], v[14:15]
  v_pk_mul_f32 v[40:41], v[40:41], v[144:145]
  v_rcp_f32 v97, v97
  v_pk_mul_f32 v[42:43], v[42:43], v[146:147]
  v_rcp_f32 v98, v98
  v_pk_mul_f32 v[44:45], v[44:45], v[152:153]
  v_rcp_f32 v99, v99
  v_pk_mul_f32 v[46:47], v[46:47], v[154:155]
  v_exp_f32 v40, v40
  v_pk_mul_f32 v[128:129], v[128:129], v[92:93]
  v_pk_mul_f32 v[130:131], v[130:131], v[94:95]
  v_exp_f32 v41, v41
  v_pk_mul_f32 v[136:137], v[136:137], v[96:97]
  v_pk_mul_f32 v[138:139], v[138:139], v[98:99]
  v_exp_f32 v42, v42
  v_cvt_pk_bf16_f32 v60, v128, v129
  v_cvt_pk_bf16_f32 v61, v130, v131
  v_exp_f32 v43, v43
  v_cvt_pk_bf16_f32 v62, v136, v137
  v_cvt_pk_bf16_f32 v63, v138, v139
  v_exp_f32 v44, v44
  buffer_store_dwordx4 v[60:63], v5, s[28:31], s25 offen sc1
  v_pk_mul_f32 v[144:145], v[144:145], v[148:149]
  v_exp_f32 v45, v45
  v_pk_mul_f32 v[146:147], v[146:147], v[150:151]
  v_exp_f32 v46, v46
  v_pk_mul_f32 v[152:153], v[152:153], v[156:157]
  v_exp_f32 v47, v47
  v_pk_mul_f32 v[154:155], v[154:155], v[158:159]
  v_pk_add_f32 v[40:41], v[40:41], 1.0 op_sel_hi:[1,0]
  v_pk_add_f32 v[42:43], v[42:43], 1.0 op_sel_hi:[1,0]
  v_pk_add_f32 v[44:45], v[44:45], 1.0 op_sel_hi:[1,0]
  v_pk_add_f32 v[46:47], v[46:47], 1.0 op_sel_hi:[1,0]
  v_rcp_f32 v40, v40
  v_pk_mul_f32 v[92:93], v[160:161], v[160:161]
  v_rcp_f32 v41, v41
  v_pk_mul_f32 v[94:95], v[162:163], v[162:163]
  v_pk_mul_f32 v[96:97], v[168:169], v[168:169]
  v_rcp_f32 v42, v42
  v_pk_mul_f32 v[98:99], v[170:171], v[170:171]
  v_pk_fma_f32 v[92:93], v[92:93], s[54:55], v[14:15]
  v_rcp_f32 v43, v43
  v_pk_fma_f32 v[94:95], v[94:95], s[54:55], v[14:15]
  v_pk_fma_f32 v[96:97], v[96:97], s[54:55], v[14:15]
  v_rcp_f32 v44, v44
  v_pk_fma_f32 v[98:99], v[98:99], s[54:55], v[14:15]
  v_pk_mul_f32 v[92:93], v[92:93], v[160:161]
  v_rcp_f32 v45, v45
  v_pk_mul_f32 v[94:95], v[94:95], v[162:163]
  v_rcp_f32 v46, v46
  v_pk_mul_f32 v[96:97], v[96:97], v[168:169]
  v_rcp_f32 v47, v47
  v_pk_mul_f32 v[98:99], v[98:99], v[170:171]
  v_exp_f32 v92, v92
  v_pk_mul_f32 v[144:145], v[144:145], v[40:41]
  v_pk_mul_f32 v[146:147], v[146:147], v[42:43]
  v_exp_f32 v93, v93
  v_pk_mul_f32 v[152:153], v[152:153], v[44:45]
  v_pk_mul_f32 v[154:155], v[154:155], v[46:47]
  v_exp_f32 v94, v94
  v_cvt_pk_bf16_f32 v64, v144, v145
  v_cvt_pk_bf16_f32 v65, v146, v147
  v_exp_f32 v95, v95
  v_cvt_pk_bf16_f32 v66, v152, v153
  v_cvt_pk_bf16_f32 v67, v154, v155
  v_exp_f32 v96, v96
  buffer_store_dwordx4 v[64:67], v5, s[28:31], s26 offen sc1
  s_waitcnt lgkmcnt(8)
  v_mfma_f32_16x16x32_bf16 v[176:179], v[24:27], v[48:51], v[176:179]
  ds_read_b64_tr_b16 v[20:21], v2 offset:27840
  v_mfma_f32_16x16x32_bf16 v[192:195], v[24:27], v[52:55], v[192:195]
  ds_read_b64_tr_b16 v[22:23], v2 offset:30144
  s_waitcnt lgkmcnt(8)
  v_mfma_f32_16x16x32_bf16 v[180:183], v[28:31], v[48:51], v[180:183]
  ds_read_b64_tr_b16 v[24:25], v2 offset:18656
  v_mfma_f32_16x16x32_bf16 v[196:199], v[28:31], v[52:55], v[196:199]
  ds_read_b64_tr_b16 v[26:27], v2 offset:20960
  s_waitcnt lgkmcnt(8)
  v_mfma_f32_16x16x32_bf16 v[184:187], v[32:35], v[48:51], v[184:187]
  ds_read_b64_tr_b16 v[28:29], v2 offset:27872
  v_mfma_f32_16x16x32_bf16 v[200:203], v[32:35], v[52:55], v[200:203]
  ds_read_b64_tr_b16 v[30:31], v2 offset:30176
  s_waitcnt lgkmcnt(8)
  v_mfma_f32_16x16x32_bf16 v[188:191], v[36:39], v[48:51], v[188:191]
  ds_read_b64_tr_b16 v[32:33], v2 offset:18688
  v_mfma_f32_16x16x32_bf16 v[204:207], v[36:39], v[52:55], v[204:207]
  ds_read_b64_tr_b16 v[34:35], v2 offset:20992
  s_waitcnt lgkmcnt(8)
  v_mfma_f32_16x16x32_bf16 v[208:211], v[16:19], v[48:51], v[208:211]
  ds_read_b64_tr_b16 v[36:37], v2 offset:27904
  v_mfma_f32_16x16x32_bf16 v[224:227], v[16:19], v[52:55], v[224:227]
  ds_read_b64_tr_b16 v[38:39], v2 offset:30208
  s_waitcnt lgkmcnt(8)
  v_mfma_f32_16x16x32_bf16 v[212:215], v[20:23], v[48:51], v[212:215]
  v_mfma_f32_16x16x32_bf16 v[228:231], v[20:23], v[52:55], v[228:231]
  s_waitcnt lgkmcnt(6)
  v_mfma_f32_16x16x32_bf16 v[216:219], v[24:27], v[48:51], v[216:219]
  v_mfma_f32_16x16x32_bf16 v[232:235], v[24:27], v[52:55], v[232:235]
  s_waitcnt lgkmcnt(4)
  v_mfma_f32_16x16x32_bf16 v[220:223], v[28:31], v[48:51], v[220:223]
  v_mfma_f32_16x16x32_bf16 v[236:239], v[28:31], v[52:55], v[236:239]
  s_waitcnt lgkmcnt(2)
  v_mfma_f32_16x16x32_bf16 v[240:243], v[32:35], v[48:51], v[240:243]
  v_mfma_f32_16x16x32_bf16 v[248:251], v[32:35], v[52:55], v[248:251]
  s_waitcnt lgkmcnt(0)
  v_mfma_f32_16x16x32_bf16 v[244:247], v[36:39], v[48:51], v[244:247]
  v_mfma_f32_16x16x32_bf16 v[252:255], v[36:39], v[52:55], v[252:255]
  v_pk_mul_f32 v[160:161], v[160:161], v[164:165]
  v_exp_f32 v97, v97
  v_pk_mul_f32 v[162:163], v[162:163], v[166:167]
  v_exp_f32 v98, v98
  v_pk_mul_f32 v[168:169], v[168:169], v[172:173]
  v_exp_f32 v99, v99
  v_pk_mul_f32 v[170:171], v[170:171], v[174:175]
  v_pk_add_f32 v[92:93], v[92:93], 1.0 op_sel_hi:[1,0]
  v_pk_add_f32 v[94:95], v[94:95], 1.0 op_sel_hi:[1,0]
  v_pk_add_f32 v[96:97], v[96:97], 1.0 op_sel_hi:[1,0]
  v_pk_add_f32 v[98:99], v[98:99], 1.0 op_sel_hi:[1,0]
  v_rcp_f32 v92, v92
  v_pk_mul_f32 v[40:41], v[176:177], v[176:177]
  v_rcp_f32 v93, v93
  v_pk_mul_f32 v[42:43], v[178:179], v[178:179]
  v_pk_mul_f32 v[44:45], v[184:185], v[184:185]
  v_rcp_f32 v94, v94
  v_pk_mul_f32 v[46:47], v[186:187], v[186:187]
  v_pk_fma_f32 v[40:41], v[40:41], s[54:55], v[14:15]
  v_rcp_f32 v95, v95
  v_pk_fma_f32 v[42:43], v[42:43], s[54:55], v[14:15]
  v_pk_fma_f32 v[44:45], v[44:45], s[54:55], v[14:15]
  v_rcp_f32 v96, v96
  v_pk_fma_f32 v[46:47], v[46:47], s[54:55], v[14:15]
  v_pk_mul_f32 v[40:41], v[40:41], v[176:177]
  v_rcp_f32 v97, v97
  v_pk_mul_f32 v[42:43], v[42:43], v[178:179]
  v_rcp_f32 v98, v98
  v_pk_mul_f32 v[44:45], v[44:45], v[184:185]
  v_rcp_f32 v99, v99
  v_pk_mul_f32 v[46:47], v[46:47], v[186:187]
  v_exp_f32 v40, v40
  v_pk_mul_f32 v[160:161], v[160:161], v[92:93]
  v_pk_mul_f32 v[162:163], v[162:163], v[94:95]
  v_exp_f32 v41, v41
  v_pk_mul_f32 v[168:169], v[168:169], v[96:97]
  v_pk_mul_f32 v[170:171], v[170:171], v[98:99]
  v_exp_f32 v42, v42
  v_cvt_pk_bf16_f32 v68, v160, v161
  v_cvt_pk_bf16_f32 v69, v162, v163
  v_exp_f32 v43, v43
  v_cvt_pk_bf16_f32 v70, v168, v169
  v_cvt_pk_bf16_f32 v71, v170, v171
  v_exp_f32 v44, v44
  buffer_store_dwordx4 v[68:71], v5, s[28:31], s27 offen sc1
  v_pk_mul_f32 v[176:177], v[176:177], v[180:181]
  v_exp_f32 v45, v45
  v_pk_mul_f32 v[178:179], v[178:179], v[182:183]
  v_exp_f32 v46, v46
  v_pk_mul_f32 v[184:185], v[184:185], v[188:189]
  v_exp_f32 v47, v47
  v_pk_mul_f32 v[186:187], v[186:187], v[190:191]
  v_pk_add_f32 v[40:41], v[40:41], 1.0 op_sel_hi:[1,0]
  v_pk_add_f32 v[42:43], v[42:43], 1.0 op_sel_hi:[1,0]
  v_pk_add_f32 v[44:45], v[44:45], 1.0 op_sel_hi:[1,0]
  v_pk_add_f32 v[46:47], v[46:47], 1.0 op_sel_hi:[1,0]
  v_rcp_f32 v40, v40
  v_pk_mul_f32 v[92:93], v[192:193], v[192:193]
  v_rcp_f32 v41, v41
  v_pk_mul_f32 v[94:95], v[194:195], v[194:195]
  v_pk_mul_f32 v[96:97], v[200:201], v[200:201]
  v_rcp_f32 v42, v42
  v_pk_mul_f32 v[98:99], v[202:203], v[202:203]
  v_pk_fma_f32 v[92:93], v[92:93], s[54:55], v[14:15]
  v_rcp_f32 v43, v43
  v_pk_fma_f32 v[94:95], v[94:95], s[54:55], v[14:15]
  v_pk_fma_f32 v[96:97], v[96:97], s[54:55], v[14:15]
  v_rcp_f32 v44, v44
  v_pk_fma_f32 v[98:99], v[98:99], s[54:55], v[14:15]
  v_pk_mul_f32 v[92:93], v[92:93], v[192:193]
  v_rcp_f32 v45, v45
  v_pk_mul_f32 v[94:95], v[94:95], v[194:195]
  v_rcp_f32 v46, v46
  v_pk_mul_f32 v[96:97], v[96:97], v[200:201]
  v_rcp_f32 v47, v47
  v_pk_mul_f32 v[98:99], v[98:99], v[202:203]
  v_exp_f32 v92, v92
  v_pk_mul_f32 v[176:177], v[176:177], v[40:41]
  v_pk_mul_f32 v[178:179], v[178:179], v[42:43]
  v_exp_f32 v93, v93
  v_pk_mul_f32 v[184:185], v[184:185], v[44:45]
  v_pk_mul_f32 v[186:187], v[186:187], v[46:47]
  v_exp_f32 v94, v94
  v_cvt_pk_bf16_f32 v72, v176, v177
  v_cvt_pk_bf16_f32 v73, v178, v179
  v_exp_f32 v95, v95
  v_cvt_pk_bf16_f32 v74, v184, v185
  v_cvt_pk_bf16_f32 v75, v186, v187
  v_exp_f32 v96, v96
  buffer_store_dwordx4 v[72:75], v5, s[28:31], s32 offen sc1
  v_pk_mul_f32 v[192:193], v[192:193], v[196:197]
  v_exp_f32 v97, v97
  v_pk_mul_f32 v[194:195], v[194:195], v[198:199]
  v_exp_f32 v98, v98
  v_pk_mul_f32 v[200:201], v[200:201], v[204:205]
  v_exp_f32 v99, v99
  v_pk_mul_f32 v[202:203], v[202:203], v[206:207]
  v_pk_add_f32 v[92:93], v[92:93], 1.0 op_sel_hi:[1,0]
  v_pk_add_f32 v[94:95], v[94:95], 1.0 op_sel_hi:[1,0]
  v_pk_add_f32 v[96:97], v[96:97], 1.0 op_sel_hi:[1,0]
  v_pk_add_f32 v[98:99], v[98:99], 1.0 op_sel_hi:[1,0]
  v_rcp_f32 v92, v92
  v_pk_mul_f32 v[40:41], v[208:209], v[208:209]
  v_rcp_f32 v93, v93
  v_pk_mul_f32 v[42:43], v[210:211], v[210:211]
  v_pk_mul_f32 v[44:45], v[216:217], v[216:217]
  v_rcp_f32 v94, v94
  v_pk_mul_f32 v[46:47], v[218:219], v[218:219]
  v_pk_fma_f32 v[40:41], v[40:41], s[54:55], v[14:15]
  v_rcp_f32 v95, v95
  v_pk_fma_f32 v[42:43], v[42:43], s[54:55], v[14:15]
  v_pk_fma_f32 v[44:45], v[44:45], s[54:55], v[14:15]
  v_rcp_f32 v96, v96
  v_pk_fma_f32 v[46:47], v[46:47], s[54:55], v[14:15]
  v_pk_mul_f32 v[40:41], v[40:41], v[208:209]
  v_rcp_f32 v97, v97
  v_pk_mul_f32 v[42:43], v[42:43], v[210:211]
  v_rcp_f32 v98, v98
  v_pk_mul_f32 v[44:45], v[44:45], v[216:217]
  v_rcp_f32 v99, v99
  v_pk_mul_f32 v[46:47], v[46:47], v[218:219]
  v_exp_f32 v40, v40
  v_pk_mul_f32 v[192:193], v[192:193], v[92:93]
  v_pk_mul_f32 v[194:195], v[194:195], v[94:95]
  v_exp_f32 v41, v41
  v_pk_mul_f32 v[200:201], v[200:201], v[96:97]
  v_pk_mul_f32 v[202:203], v[202:203], v[98:99]
  v_exp_f32 v42, v42
  v_cvt_pk_bf16_f32 v76, v192, v193
  v_cvt_pk_bf16_f32 v77, v194, v195
  v_exp_f32 v43, v43
  v_cvt_pk_bf16_f32 v78, v200, v201
  v_cvt_pk_bf16_f32 v79, v202, v203
  v_exp_f32 v44, v44
  buffer_store_dwordx4 v[76:79], v5, s[28:31], s33 offen sc1
  s_mov_b64 exec, 1
  ds_add_u32 v1, v10 offset:12
  s_mov_b64 exec, -1
  v_pk_mul_f32 v[208:209], v[208:209], v[212:213]
  v_exp_f32 v45, v45
  v_pk_mul_f32 v[210:211], v[210:211], v[214:215]
  v_exp_f32 v46, v46
  v_pk_mul_f32 v[216:217], v[216:217], v[220:221]
  v_exp_f32 v47, v47
  v_pk_mul_f32 v[218:219], v[218:219], v[222:223]
  v_pk_add_f32 v[40:41], v[40:41], 1.0 op_sel_hi:[1,0]
  v_pk_add_f32 v[42:43], v[42:43], 1.0 op_sel_hi:[1,0]
  v_pk_add_f32 v[44:45], v[44:45], 1.0 op_sel_hi:[1,0]
  v_pk_add_f32 v[46:47], v[46:47], 1.0 op_sel_hi:[1,0]
  v_rcp_f32 v40, v40
  v_pk_mul_f32 v[92:93], v[224:225], v[224:225]
  v_rcp_f32 v41, v41
  v_pk_mul_f32 v[94:95], v[226:227], v[226:227]
  v_pk_mul_f32 v[96:97], v[232:233], v[232:233]
  v_rcp_f32 v42, v42
  v_pk_mul_f32 v[98:99], v[234:235], v[234:235]
  v_pk_fma_f32 v[92:93], v[92:93], s[54:55], v[14:15]
  v_rcp_f32 v43, v43
  v_pk_fma_f32 v[94:95], v[94:95], s[54:55], v[14:15]
  v_pk_fma_f32 v[96:97], v[96:97], s[54:55], v[14:15]
  v_rcp_f32 v44, v44
  v_pk_fma_f32 v[98:99], v[98:99], s[54:55], v[14:15]
  v_pk_mul_f32 v[92:93], v[92:93], v[224:225]
  v_rcp_f32 v45, v45
  v_pk_mul_f32 v[94:95], v[94:95], v[226:227]
  v_rcp_f32 v46, v46
  v_pk_mul_f32 v[96:97], v[96:97], v[232:233]
  v_rcp_f32 v47, v47
  v_pk_mul_f32 v[98:99], v[98:99], v[234:235]
  v_exp_f32 v92, v92
  v_pk_mul_f32 v[208:209], v[208:209], v[40:41]
  v_pk_mul_f32 v[210:211], v[210:211], v[42:43]
  v_exp_f32 v93, v93
  v_pk_mul_f32 v[216:217], v[216:217], v[44:45]
  v_pk_mul_f32 v[218:219], v[218:219], v[46:47]
  v_exp_f32 v94, v94
  v_cvt_pk_bf16_f32 v80, v208, v209
  v_cvt_pk_bf16_f32 v81, v210, v211
  v_exp_f32 v95, v95
  v_cvt_pk_bf16_f32 v82, v216, v217
  v_cvt_pk_bf16_f32 v83, v218, v219
  v_exp_f32 v96, v96
  buffer_store_dwordx4 v[80:83], v5, s[28:31], s34 offen sc1
  s_waitcnt vmcnt(4)
  v_add_u32 v104, 1, v11
  s_mov_b64 exec, 1
  buffer_store_dword v104, v105, s[28:31], s43 offen offset:0 sc1
  s_mov_b64 exec, -1
  ds_read_b32 v4, v1 offset:64
  v_pk_mul_f32 v[224:225], v[224:225], v[228:229]
  v_exp_f32 v97, v97
  v_pk_mul_f32 v[226:227], v[226:227], v[230:231]
  v_exp_f32 v98, v98
  v_pk_mul_f32 v[232:233], v[232:233], v[236:237]
  v_exp_f32 v99, v99
  v_pk_mul_f32 v[234:235], v[234:235], v[238:239]
  v_pk_add_f32 v[92:93], v[92:93], 1.0 op_sel_hi:[1,0]
  v_pk_add_f32 v[94:95], v[94:95], 1.0 op_sel_hi:[1,0]
  v_pk_add_f32 v[96:97], v[96:97], 1.0 op_sel_hi:[1,0]
  v_pk_add_f32 v[98:99], v[98:99], 1.0 op_sel_hi:[1,0]
  v_rcp_f32 v92, v92
  v_pk_mul_f32 v[40:41], v[240:241], v[240:241]
  v_rcp_f32 v93, v93
  v_pk_mul_f32 v[42:43], v[242:243], v[242:243]
  v_pk_mul_f32 v[44:45], v[248:249], v[248:249]
  v_rcp_f32 v94, v94
  v_pk_mul_f32 v[46:47], v[250:251], v[250:251]
  v_pk_fma_f32 v[40:41], v[40:41], s[54:55], v[14:15]
  v_rcp_f32 v95, v95
  v_pk_fma_f32 v[42:43], v[42:43], s[54:55], v[14:15]
  v_pk_fma_f32 v[44:45], v[44:45], s[54:55], v[14:15]
  v_rcp_f32 v96, v96
  v_pk_fma_f32 v[46:47], v[46:47], s[54:55], v[14:15]
  v_pk_mul_f32 v[40:41], v[40:41], v[240:241]
  v_rcp_f32 v97, v97
  v_pk_mul_f32 v[42:43], v[42:43], v[242:243]
  v_rcp_f32 v98, v98
  v_pk_mul_f32 v[44:45], v[44:45], v[248:249]
  v_rcp_f32 v99, v99
  v_pk_mul_f32 v[46:47], v[46:47], v[250:251]
  v_exp_f32 v40, v40
  v_pk_mul_f32 v[224:225], v[224:225], v[92:93]
  v_pk_mul_f32 v[226:227], v[226:227], v[94:95]
  v_exp_f32 v41, v41
  v_pk_mul_f32 v[232:233], v[232:233], v[96:97]
  v_pk_mul_f32 v[234:235], v[234:235], v[98:99]
  v_exp_f32 v42, v42
  v_cvt_pk_bf16_f32 v84, v224, v225
  v_cvt_pk_bf16_f32 v85, v226, v227
  v_exp_f32 v43, v43
  v_cvt_pk_bf16_f32 v86, v232, v233
  v_cvt_pk_bf16_f32 v87, v234, v235
  v_exp_f32 v44, v44
  buffer_store_dwordx4 v[84:87], v5, s[28:31], s35 offen sc1
  s_waitcnt lgkmcnt(0)
  v_readfirstlane_b32 s60, v4
  s_cmp_ge_u32 s60, 3
  s_cbranch_scc0 L_slow11
L_back12:
  ds_read_b64_tr_b16 v[16:17], v6 offset:0
  ds_read_b64_tr_b16 v[18:19], v6 offset:4608
  ds_read_b64_tr_b16 v[20:21], v6 offset:32
  ds_read_b64_tr_b16 v[22:23], v6 offset:4640
  ds_read_b64_tr_b16 v[24:25], v6 offset:64
  ds_read_b64_tr_b16 v[26:27], v6 offset:4672
  ds_read_b64_tr_b16 v[28:29], v6 offset:96
  ds_read_b64_tr_b16 v[30:31], v6 offset:4704
  ds_read_b64_tr_b16 v[32:33], v6 offset:128
  ds_read_b64_tr_b16 v[34:35], v6 offset:4736
  ds_read_b32 v3, v106 offset:32
  v_pk_mul_f32 v[240:241], v[240:241], v[244:245]
  v_exp_f32 v45, v45
  v_pk_mul_f32 v[242:243], v[242:243], v[246:247]
  v_exp_f32 v46, v46
  v_pk_mul_f32 v[248:249], v[248:249], v[252:253]
  v_exp_f32 v47, v47
  v_pk_mul_f32 v[250:251], v[250:251], v[254:255]
  v_pk_add_f32 v[40:41], v[40:41], 1.0 op_sel_hi:[1,0]
  v_pk_add_f32 v[42:43], v[42:43], 1.0 op_sel_hi:[1,0]
  v_pk_add_f32 v[44:45], v[44:45], 1.0 op_sel_hi:[1,0]
  v_pk_add_f32 v[46:47], v[46:47], 1.0 op_sel_hi:[1,0]
  v_rcp_f32 v40, v40
  v_rcp_f32 v41, v41
  v_rcp_f32 v42, v42
  v_rcp_f32 v43, v43
  v_rcp_f32 v44, v44
  v_rcp_f32 v45, v45
  v_rcp_f32 v46, v46
  v_rcp_f32 v47, v47
  s_nop 0
  v_pk_mul_f32 v[240:241], v[240:241], v[40:41]
  v_pk_mul_f32 v[242:243], v[242:243], v[42:43]
  v_pk_mul_f32 v[248:249], v[248:249], v[44:45]
  v_pk_mul_f32 v[250:251], v[250:251], v[46:47]
  v_cvt_pk_bf16_f32 v88, v240, v241
  v_cvt_pk_bf16_f32 v89, v242, v243
  v_cvt_pk_bf16_f32 v90, v248, v249
  v_cvt_pk_bf16_f32 v91, v250, v251
  buffer_store_dwordx4 v[88:91], v5, s[28:31], s36 offen sc1
  s_mov_b64 exec, 1
  ds_add_u32 v1, v10 offset:4
  s_mov_b64 exec, -1
  s_waitcnt vmcnt(4)
  v_add_u32 v104, 2, v11
  s_mov_b64 exec, 1
  buffer_store_dword v104, v105, s[28:31], s43 offen offset:0 sc1
  s_mov_b64 exec, -1
  s_waitcnt lgkmcnt(0)
  v_readfirstlane_b32 s42, v3
  s_cmp_ge_u32 s42, 1
  s_cbranch_scc0 L_noearly
  buffer_load_dwordx4 v[112:115], v9, s[28:31], s24 offen sc1
  buffer_load_dwordx4 v[116:119], v9, s[28:31], s25 offen sc1
  buffer_load_dwordx4 v[120:123], v9, s[28:31], s26 offen sc1
  buffer_load_dwordx4 v[124:127], v12, s[28:31], s24 offen sc1
  buffer_load_dwordx4 v[128:131], v12, s[28:31], s25 offen sc1
  buffer_load_dwordx4 v[132:135], v12, s[28:31], s26 offen sc1
  buffer_load_dwordx4 v[136:139], v13, s[28:31], s24 offen sc1
  buffer_load_dwordx4 v[140:143], v13, s[28:31], s25 offen sc1
  buffer_load_dwordx4 v[144:147], v13, s[28:31], s26 offen sc1
L_noearly:
  v_mov_b32 v40, v88
  v_mov_b32 v41, v89
  v_mov_b32 v44, v90
  v_mov_b32 v45, v91
  v_mfma_f32_16x16x32_bf16 v[184:187], v[16:19], v[56:59], 0
  ds_read_b64_tr_b16 v[36:37], v6 offset:160
  v_mfma_f32_16x16x32_bf16 v[188:191], v[16:19], v[60:63], 0
  ds_read_b64_tr_b16 v[38:39], v6 offset:4768
  v_mfma_f32_16x16x32_bf16 v[192:195], v[20:23], v[56:59], 0
  ds_read_b64_tr_b16 v[16:17], v6 offset:192
  v_mfma_f32_16x16x32_bf16 v[196:199], v[20:23], v[60:63], 0
  ds_read_b64_tr_b16 v[18:19], v6 offset:4800
  v_mfma_f32_16x16x32_bf16 v[200:203], v[24:27], v[56:59], 0
  ds_read_b64_tr_b16 v[20:21], v6 offset:224
  v_mfma_f32_16x16x32_bf16 v[204:207], v[24:27], v[60:63], 0
  ds_read_b64_tr_b16 v[22:23], v6 offset:4832
  v_mfma_f32_16x16x32_bf16 v[208:211], v[28:31], v[56:59], 0
  ds_read_b64_tr_b16 v[24:25], v6 offset:256
  v_mfma_f32_16x16x32_bf16 v[212:215], v[28:31], v[60:63], 0
  ds_read_b64_tr_b16 v[26:27], v6 offset:4864
  v_mfma_f32_16x16x32_bf16 v[216:219], v[32:35], v[56:59], 0
  ds_read_b64_tr_b16 v[28:29], v6 offset:9216
  v_mfma_f32_16x16x32_bf16 v[220:223], v[32:35], v[60:63], 0
  ds_read_b64_tr_b16 v[30:31], v6 offset:13824
  s_waitcnt lgkmcnt(8)
  v_mfma_f32_16x16x32_bf16 v[224:227], v[36:39], v[56:59], 0
  ds_read_b64_tr_b16 v[32:33], v6 offset:9248
  v_mfma_f32_16x16x32_bf16 v[228:231], v[36:39], v[60:63], 0
  ds_read_b64_tr_b16 v[34:35], v6 offset:13856
  s_waitcnt lgkmcnt(8)
  v_mfma_f32_16x16x32_bf16 v[232:235], v[16:19], v[56:59], 0
  ds_read_b64_tr_b16 v[36:37], v6 offset:9280
  v_mfma_f32_16x16x32_bf16 v[236:239], v[16:19], v[60:63], 0
  ds_read_b64_tr_b16 v[38:39], v6 offset:13888
  s_waitcnt lgkmcnt(8)
  v_mfma_f32_16x16x32_bf16 v[240:243], v[20:23], v[56:59], 0
  ds_read_b64_tr_b16 v[16:17], v6 offset:9312
  v_mfma_f32_16x16x32_bf16 v[244:247], v[20:23], v[60:63], 0
  ds_read_b64_tr_b16 v[18:19], v6 offset:13920
  s_waitcnt lgkmcnt(8)
  v_mfma_f32_16x16x32_bf16 v[248:251], v[24:27], v[56:59], 0
  ds_read_b64_tr_b16 v[20:21], v6 offset:9344
  v_mfma_f32_16x16x32_bf16 v[252:255], v[24:27], v[60:63], 0
  ds_read_b64_tr_b16 v[22:23], v6 offset:13952
  s_waitcnt lgkmcnt(8)
  v_mfma_f32_16x16x32_bf16 v[184:187], v[28:31], v[64:67], v[184:187]
  ds_read_b64_tr_b16 v[24:25], v6 offset:9376
  v_mfma_f32_16x16x32_bf16 v[188:191], v[28:31], v[68:71], v[188:191]
  ds_read_b64_tr_b16 v[26:27], v6 offset:13984
  ds_read_b32 v2, v106 offset:32
  s_waitcnt lgkmcnt(9)
  v_mfma_f32_16x16x32_bf16 v[192:195], v[32:35], v[64:67], v[192:195]
  ds_read_b64_tr_b16 v[28:29], v6 offset:9408
  v_mfma_f32_16x16x32_bf16 v[196:199], v[32:35], v[68:71], v[196:199]
  ds_read_b64_tr_b16 v[30:31], v6 offset:14016
  s_waitcnt lgkmcnt(9)
  v_mfma_f32_16x16x32_bf16 v[200:203], v[36:39], v[64:67], v[200:203]
  ds_read_b64_tr_b16 v[32:33], v6 offset:9440
  v_mfma_f32_16x16x32_bf16 v[204:207], v[36:39], v[68:71], v[204:207]
  ds_read_b64_tr_b16 v[34:35], v6 offset:14048
  s_waitcnt lgkmcnt(9)
  v_mfma_f32_16x16x32_bf16 v[208:211], v[16:19], v[64:67], v[208:211]
  ds_read_b64_tr_b16 v[36:37], v6 offset:9472
  v_mfma_f32_16x16x32_bf16 v[212:215], v[16:19], v[68:71], v[212:215]
  ds_read_b64_tr_b16 v[38:39], v6 offset:14080
  s_waitcnt lgkmcnt(9)
  v_mfma_f32_16x16x32_bf16 v[216:219], v[20:23], v[64:67], v[216:219]
  ds_read_b64_tr_b16 v[16:17], v6 offset:18432
  v_mfma_f32_16x16x32_bf16 v[220:223], v[20:23], v[68:71], v[220:223]
  ds_read_b64_tr_b16 v[18:19], v6 offset:23040
  s_waitcnt vmcnt(0)
  v_add_u32 v104, 3, v11
  s_mov_b64 exec, 1
  buffer_store_dword v104, v105, s[28:31], s43 offen offset:0 sc1
  s_mov_b64 exec, -1
  s_waitcnt lgkmcnt(8)
  s_cmp_ge_u32 s42, 1
  s_cbranch_scc1 L_skipA
  v_readfirstlane_b32 s60, v2
  s_cmp_ge_u32 s60, 1
  s_cbranch_scc0 L_slow13
L_back14:
  buffer_load_dwordx4 v[112:115], v9, s[28:31], s24 offen sc1
  buffer_load_dwordx4 v[116:119], v9, s[28:31], s25 offen sc1
  buffer_load_dwordx4 v[120:123], v9, s[28:31], s26 offen sc1
  buffer_load_dwordx4 v[124:127], v12, s[28:31], s24 offen sc1
  buffer_load_dwordx4 v[128:131], v12, s[28:31], s25 offen sc1
  buffer_load_dwordx4 v[132:135], v12, s[28:31], s26 offen sc1
  buffer_load_dwordx4 v[136:139], v13, s[28:31], s24 offen sc1
  buffer_load_dwordx4 v[140:143], v13, s[28:31], s25 offen sc1
  buffer_load_dwordx4 v[144:147], v13, s[28:31], s26 offen sc1
L_skipA:
  v_mfma_f32_16x16x32_bf16 v[224:227], v[24:27], v[64:67], v[224:227]
  ds_read_b64_tr_b16 v[20:21], v6 offset:18464
  v_mfma_f32_16x16x32_bf16 v[228:231], v[24:27], v[68:71], v[228:231]
  ds_read_b64_tr_b16 v[22:23], v6 offset:23072
  s_waitcnt lgkmcnt(8)
  v_mfma_f32_16x16x32_bf16 v[232:235], v[28:31], v[64:67], v[232:235]
  ds_read_b64_tr_b16 v[24:25], v6 offset:18496
  v_mfma_f32_16x16x32_bf16 v[236:239], v[28:31], v[68:71], v[236:239]
  ds_read_b64_tr_b16 v[26:27], v6 offset:23104
  s_waitcnt lgkmcnt(8)
  v_mfma_f32_16x16x32_bf16 v[240:243], v[32:35], v[64:67], v[240:243]
  ds_read_b64_tr_b16 v[28:29], v6 offset:18528
  v_mfma_f32_16x16x32_bf16 v[244:247], v[32:35], v[68:71], v[244:247]
  ds_read_b64_tr_b16 v[30:31], v6 offset:23136
  s_waitcnt lgkmcnt(8)
  v_mfma_f32_16x16x32_bf16 v[248:251], v[36:39], v[64:67], v[248:251]
  ds_read_b64_tr_b16 v[32:33], v6 offset:18560
  v_mfma_f32_16x16x32_bf16 v[252:255], v[36:39], v[68:71], v[252:255]
  ds_read_b64_tr_b16 v[34:35], v6 offset:23168
  s_mov_b64 exec, 1
  ds_add_u32 v1, v10 offset:8
  s_mov_b64 exec, -1
  s_waitcnt lgkmcnt(9)
  v_mfma_f32_16x16x32_bf16 v[184:187], v[16:19], v[72:75], v[184:187]
  ds_read_b64_tr_b16 v[36:37], v6 offset:18592
  v_mfma_f32_16x16x32_bf16 v[188:191], v[16:19], v[76:79], v[188:191]
  ds_read_b64_tr_b16 v[38:39], v6 offset:23200
  s_waitcnt lgkmcnt(9)
  v_mfma_f32_16x16x32_bf16 v[192:195], v[20:23], v[72:75], v[192:195]
  ds_read_b64_tr_b16 v[16:17], v6 offset:18624
  v_mfma_f32_16x16x32_bf16 v[196:199], v[20:23], v[76:79], v[196:199]
  ds_read_b64_tr_b16 v[18:19], v6 offset:23232
  s_waitcnt lgkmcnt(9)
  v_mfma_f32_16x16x32_bf16 v[200:203], v[24:27], v[72:75], v[200:203]
  ds_read_b64_tr_b16 v[20:21], v6 offset:18656
  v_mfma_f32_16x16x32_bf16 v[204:207], v[24:27], v[76:79], v[204:207]
  ds_read_b64_tr_b16 v[22:23], v6 offset:23264
  s_waitcnt lgkmcnt(9)
  v_mfma_f32_16x16x32_bf16 v[208:211], v[28:31], v[72:75], v[208:211]
  ds_read_b64_tr_b16 v[24:25], v6 offset:18688
  v_mfma_f32_16x16x32_bf16 v[212:215], v[28:31], v[76:79], v[212:215]
  ds_read_b64_tr_b16 v[26:27], v6 offset:23296
  s_waitcnt lgkmcnt(9)
  v_mfma_f32_16x16x32_bf16 v[216:219], v[32:35], v[72:75], v[216:219]
  ds_read_b64_tr_b16 v[28:29], v6 offset:27648
  v_mfma_f32_16x16x32_bf16 v[220:223], v[32:35], v[76:79], v[220:223]
  ds_read_b64_tr_b16 v[30:31], v6 offset:32256
  s_waitcnt lgkmcnt(8)
  v_mfma_f32_16x16x32_bf16 v[224:227], v[36:39], v[72:75], v[224:227]
  ds_read_b64_tr_b16 v[32:33], v6 offset:27680
  v_mfma_f32_16x16x32_bf16 v[228:231], v[36:39], v[76:79], v[228:231]
  ds_read_b64_tr_b16 v[34:35], v6 offset:32288
  s_waitcnt lgkmcnt(8)
  v_mfma_f32_16x16x32_bf16 v[232:235], v[16:19], v[72:75], v[232:235]
  ds_read_b64_tr_b16 v[36:37], v6 offset:27712
  v_mfma_f32_16x16x32_bf16 v[236:239], v[16:19], v[76:79], v[236:239]
  ds_read_b64_tr_b16 v[38:39], v6 offset:32320
  s_waitcnt lgkmcnt(8)
  v_mfma_f32_16x16x32_bf16 v[240:243], v[20:23], v[72:75], v[240:243]
  ds_read_b64_tr_b16 v[16:17], v6 offset:27744
  v_mfma_f32_16x16x32_bf16 v[244:247], v[20:23], v[76:79], v[244:247]
  ds_read_b64_tr_b16 v[18:19], v6 offset:32352
  s_waitcnt lgkmcnt(8)
  v_mfma_f32_16x16x32_bf16 v[248:251], v[24:27], v[72:75], v[248:251]
  ds_read_b64_tr_b16 v[20:21], v6 offset:27776
  v_mfma_f32_16x16x32_bf16 v[252:255], v[24:27], v[76:79], v[252:255]
  ds_read_b64_tr_b16 v[22:23], v6 offset:32384
  ds_read_b32 v3, v1 offset:68
  s_waitcnt lgkmcnt(9)
  v_mfma_f32_16x16x32_bf16 v[184:187], v[28:31], v[80:83], v[184:187]
  ds_read_b64_tr_b16 v[24:25], v6 offset:27808
  v_mfma_f32_16x16x32_bf16 v[188:191], v[28:31], v[84:87], v[188:191]
  ds_read_b64_tr_b16 v[26:27], v6 offset:32416
  s_waitcnt lgkmcnt(9)
  v_mfma_f32_16x16x32_bf16 v[192:195], v[32:35], v[80:83], v[192:195]
  ds_read_b64_tr_b16 v[28:29], v6 offset:27840
  v_mfma_f32_16x16x32_bf16 v[196:199], v[32:35], v[84:87], v[196:199]
  ds_read_b64_tr_b16 v[30:31], v6 offset:32448
  s_waitcnt lgkmcnt(9)
  v_mfma_f32_16x16x32_bf16 v[200:203], v[36:39], v[80:83], v[200:203]
  ds_read_b64_tr_b16 v[32:33], v6 offset:27872
  v_mfma_f32_16x16x32_bf16 v[204:207], v[36:39], v[84:87], v[204:207]
  ds_read_b64_tr_b16 v[34:35], v6 offset:32480
  s_waitcnt lgkmcnt(9)
  v_mfma_f32_16x16x32_bf16 v[208:211], v[16:19], v[80:83], v[208:211]
  ds_read_b64_tr_b16 v[36:37], v6 offset:27904
  v_mfma_f32_16x16x32_bf16 v[212:215], v[16:19], v[84:87], v[212:215]
  ds_read_b64_tr_b16 v[38:39], v6 offset:32512
  s_waitcnt lgkmcnt(8)
  v_readfirstlane_b32 s60, v3
  s_cmp_ge_u32 s60, 3
  s_cbranch_scc0 L_slow15
L_back16:
  v_mfma_f32_16x16x32_bf16 v[216:219], v[20:23], v[80:83], v[216:219]
  ds_read_b64_tr_b16 v[16:17], v6 offset:36864
  v_mfma_f32_16x16x32_bf16 v[220:223], v[20:23], v[84:87], v[220:223]
  ds_read_b64_tr_b16 v[18:19], v6 offset:41472
  s_waitcnt lgkmcnt(8)
  v_mfma_f32_16x16x32_bf16 v[224:227], v[24:27], v[80:83], v[224:227]
  ds_read_b64_tr_b16 v[20:21], v6 offset:36896
  v_mfma_f32_16x16x32_bf16 v[228:231], v[24:27], v[84:87], v[228:231]
  ds_read_b64_tr_b16 v[22:23], v6 offset:41504
  s_waitcnt lgkmcnt(8)
  v_mfma_f32_16x16x32_bf16 v[232:235], v[28:31], v[80:83], v[232:235]
  ds_read_b64_tr_b16 v[24:25], v6 offset:36928
  v_mfma_f32_16x16x32_bf16 v[236:239], v[28:31], v[84:87], v[236:239]
  ds_read_b64_tr_b16 v[26:27], v6 offset:41536
  s_waitcnt lgkmcnt(8)
  v_mfma_f32_16x16x32_bf16 v[240:243], v[32:35], v[80:83], v[240:243]
  ds_read_b64_tr_b16 v[28:29], v6 offset:36960
  v_mfma_f32_16x16x32_bf16 v[244:247], v[32:35], v[84:87], v[244:247]
  ds_read_b64_tr_b16 v[30:31], v6 offset:41568
  s_waitcnt lgkmcnt(8)
  v_mfma_f32_16x16x32_bf16 v[248:251], v[36:39], v[80:83], v[248:251]
  ds_read_b64_tr_b16 v[32:33], v6 offset:36992
  v_mfma_f32_16x16x32_bf16 v[252:255], v[36:39], v[84:87], v[252:255]
  ds_read_b64_tr_b16 v[34:35], v6 offset:41600
  ds_read_b32 v4, v106 offset:32
  s_waitcnt vmcnt(6)
  s_waitcnt lgkmcnt(9)
  v_mfma_f32_16x16x32_bf16 v[184:187], v[16:19], v[112:115], v[184:187]
  ds_read_b64_tr_b16 v[36:37], v6 offset:37024
  v_mfma_f32_16x16x32_bf16 v[188:191], v[16:19], v[116:119], v[188:191]
  ds_read_b64_tr_b16 v[38:39], v6 offset:41632
  s_waitcnt lgkmcnt(9)
  v_mfma_f32_16x16x32_bf16 v[192:195], v[20:23], v[112:115], v[192:195]
  ds_read_b64_tr_b16 v[16:17], v6 offset:37056
  v_mfma_f32_16x16x32_bf16 v[196:199], v[20:23], v[116:119], v[196:199]
  ds_read_b64_tr_b16 v[18:19], v6 offset:41664
  s_waitcnt lgkmcnt(9)
  v_mfma_f32_16x16x32_bf16 v[200:203], v[24:27], v[112:115], v[200:203]
  ds_read_b64_tr_b16 v[20:21], v6 offset:37088
  v_mfma_f32_16x16x32_bf16 v[204:207], v[24:27], v[116:119], v[204:207]
  ds_read_b64_tr_b16 v[22:23], v6 offset:41696
  s_waitcnt lgkmcnt(9)
  v_mfma_f32_16x16x32_bf16 v[208:211], v[28:31], v[112:115], v[208:211]
  ds_read_b64_tr_b16 v[24:25], v6 offset:37120
  v_mfma_f32_16x16x32_bf16 v[212:215], v[28:31], v[116:119], v[212:215]
  ds_read_b64_tr_b16 v[26:27], v6 offset:41728
  s_waitcnt lgkmcnt(8)
  v_readfirstlane_b32 s60, v4
  s_cmp_ge_u32 s60, 2
  s_cbranch_scc0 L_slow17
L_back18:
  buffer_load_dwordx4 v[148:151], v9, s[28:31], s27 offen sc1
  buffer_load_dwordx4 v[152:155], v9, s[28:31], s32 offen sc1
  buffer_load_dwordx4 v[156:159], v9, s[28:31], s33 offen sc1
  v_mfma_f32_16x16x32_bf16 v[216:219], v[32:35], v[112:115], v[216:219]
  ds_read_b64_tr_b16 v[28:29], v6 offset:46080
  v_mfma_f32_16x16x32_bf16 v[220:223], v[32:35], v[116:119], v[220:223]
  ds_read_b64_tr_b16 v[30:31], v6 offset:50688
  s_waitcnt lgkmcnt(8)
  v_mfma_f32_16x16x32_bf16 v[224:227], v[36:39], v[112:115], v[224:227]
  ds_read_b64_tr_b16 v[32:33], v6 offset:46112
  v_mfma_f32_16x16x32_bf16 v[228:231], v[36:39], v[116:119], v[228:231]
  ds_read_b64_tr_b16 v[34:35], v6 offset:50720
  buffer_load_dwordx4 v[160:163], v12, s[28:31], s27 offen sc1
  buffer_load_dwordx4 v[164:167], v12, s[28:31], s32 offen sc1
  buffer_load_dwordx4 v[168:171], v12, s[28:31], s33 offen sc1
  s_waitcnt lgkmcnt(8)
  v_mfma_f32_16x16x32_bf16 v[232:235], v[16:19], v[112:115], v[232:235]
  ds_read_b64_tr_b16 v[36:37], v6 offset:46144
  v_mfma_f32_16x16x32_bf16 v[236:239], v[16:19], v[116:119], v[236:239]
  ds_read_b64_tr_b16 v[38:39], v6 offset:50752
  s_waitcnt lgkmcnt(8)
  v_mfma_f32_16x16x32_bf16 v[240:243], v[20:23], v[112:115], v[240:243]
  ds_read_b64_tr_b16 v[16:17], v6 offset:46176
  v_mfma_f32_16x16x32_bf16 v[244:247], v[20:23], v[116:119], v[244:247]
  ds_read_b64_tr_b16 v[18:19], v6 offset:50784
  buffer_load_dwordx4 v[172:175], v13, s[28:31], s27 offen sc1
  buffer_load_dwordx4 v[176:179], v13, s[28:31], s32 offen sc1
  buffer_load_dwordx4 v[180:183], v13, s[28:31], s33 offen sc1
  s_waitcnt lgkmcnt(8)
  v_mfma_f32_16x16x32_bf16 v[248:251], v[24:27], v[112:115], v[248:251]
  ds_read_b64_tr_b16 v[20:21], v6 offset:46208
  v_mfma_f32_16x16x32_bf16 v[252:255], v[24:27], v[116:119], v[252:255]
  ds_read_b64_tr_b16 v[22:23], v6 offset:50816
  s_waitcnt vmcnt(12)
  s_waitcnt lgkmcnt(8)
  v_mfma_f32_16x16x32_bf16 v[184:187], v[28:31], v[124:127], v[184:187]
  ds_read_b64_tr_b16 v[24:25], v6 offset:46240
  v_mfma_f32_16x16x32_bf16 v[188:191], v[28:31], v[128:131], v[188:191]
  ds_read_b64_tr_b16 v[26:27], v6 offset:50848
  s_waitcnt lgkmcnt(8)
  v_mfma_f32_16x16x32_bf16 v[192:195], v[32:35], v[124:127], v[192:195]
  ds_read_b64_tr_b16 v[28:29], v6 offset:46272
  v_mfma_f32_16x16x32_bf16 v[196:199], v[32:35], v[128:131], v[196:199]
  ds_read_b64_tr_b16 v[30:31], v6 offset:50880
  s_waitcnt lgkmcnt(8)
  v_mfma_f32_16x16x32_bf16 v[200:203], v[36:39], v[124:127], v[200:203]
  ds_read_b64_tr_b16 v[32:33], v6 offset:46304
  v_mfma_f32_16x16x32_bf16 v[204:207], v[36:39], v[128:131], v[204:207]
  ds_read_b64_tr_b16 v[34:35], v6 offset:50912
  s_waitcnt lgkmcnt(8)
  v_mfma_f32_16x16x32_bf16 v[208:211], v[16:19], v[124:127], v[208:211]
  ds_read_b64_tr_b16 v[36:37], v6 offset:46336
  v_mfma_f32_16x16x32_bf16 v[212:215], v[16:19], v[128:131], v[212:215]
  ds_read_b64_tr_b16 v[38:39], v6 offset:50944
  s_waitcnt lgkmcnt(8)
  v_mfma_f32_16x16x32_bf16 v[216:219], v[20:23], v[124:127], v[216:219]
  ds_read_b64_tr_b16 v[16:17], v7 offset:0
  v_mfma_f32_16x16x32_bf16 v[220:223], v[20:23], v[128:131], v[220:223]
  ds_read_b64_tr_b16 v[18:19], v7 offset:4608
  s_waitcnt lgkmcnt(8)
  v_mfma_f32_16x16x32_bf16 v[224:227], v[24:27], v[124:127], v[224:227]
  ds_read_b64_tr_b16 v[20:21], v7 offset:32
  v_mfma_f32_16x16x32_bf16 v[228:231], v[24:27], v[128:131], v[228:231]
  ds_read_b64_tr_b16 v[22:23], v7 offset:4640
  s_waitcnt lgkmcnt(8)
  v_mfma_f32_16x16x32_bf16 v[232:235], v[28:31], v[124:127], v[232:235]
  ds_read_b64_tr_b16 v[24:25], v7 offset:64
  v_mfma_f32_16x16x32_bf16 v[236:239], v[28:31], v[128:131], v[236:239]
  ds_read_b64_tr_b16 v[26:27], v7 offset:4672
  s_waitcnt lgkmcnt(8)
  v_mfma_f32_16x16x32_bf16 v[240:243], v[32:35], v[124:127], v[240:243]
  ds_read_b64_tr_b16 v[28:29], v7 offset:96
  v_mfma_f32_16x16x32_bf16 v[244:247], v[32:35], v[128:131], v[244:247]
  ds_read_b64_tr_b16 v[30:31], v7 offset:4704
  s_waitcnt lgkmcnt(8)
  v_mfma_f32_16x16x32_bf16 v[248:251], v[36:39], v[124:127], v[248:251]
  ds_read_b64_tr_b16 v[32:33], v7 offset:128
  v_mfma_f32_16x16x32_bf16 v[252:255], v[36:39], v[128:131], v[252:255]
  ds_read_b64_tr_b16 v[34:35], v7 offset:4736
  s_waitcnt vmcnt(9)
  s_waitcnt lgkmcnt(8)
  v_mfma_f32_16x16x32_bf16 v[184:187], v[16:19], v[136:139], v[184:187]
  ds_read_b64_tr_b16 v[36:37], v7 offset:160
  v_mfma_f32_16x16x32_bf16 v[188:191], v[16:19], v[140:143], v[188:191]
  ds_read_b64_tr_b16 v[38:39], v7 offset:4768
  s_waitcnt lgkmcnt(8)
  v_mfma_f32_16x16x32_bf16 v[192:195], v[20:23], v[136:139], v[192:195]
  ds_read_b64_tr_b16 v[16:17], v7 offset:192
  v_mfma_f32_16x16x32_bf16 v[196:199], v[20:23], v[140:143], v[196:199]
  ds_read_b64_tr_b16 v[18:19], v7 offset:4800
  s_waitcnt lgkmcnt(8)
  v_mfma_f32_16x16x32_bf16 v[200:203], v[24:27], v[136:139], v[200:203]
  ds_read_b64_tr_b16 v[20:21], v7 offset:224
  v_mfma_f32_16x16x32_bf16 v[204:207], v[24:27], v[140:143], v[204:207]
  ds_read_b64_tr_b16 v[22:23], v7 offset:4832
  s_waitcnt lgkmcnt(8)
  v_mfma_f32_16x16x32_bf16 v[208:211], v[28:31], v[136:139], v[208:211]
  ds_read_b64_tr_b16 v[24:25], v7 offset:256
  v_mfma_f32_16x16x32_bf16 v[212:215], v[28:31], v[140:143], v[212:215]
  ds_read_b64_tr_b16 v[26:27], v7 offset:4864
  s_waitcnt lgkmcnt(8)
  v_mfma_f32_16x16x32_bf16 v[216:219], v[32:35], v[136:139], v[216:219]
  ds_read_b64_tr_b16 v[28:29], v7 offset:9216
  v_mfma_f32_16x16x32_bf16 v[220:223], v[32:35], v[140:143], v[220:223]
  ds_read_b64_tr_b16 v[30:31], v7 offset:13824
  s_waitcnt lgkmcnt(8)
  v_mfma_f32_16x16x32_bf16 v[224:227], v[36:39], v[136:139], v[224:227]
  ds_read_b64_tr_b16 v[32:33], v7 offset:9248
  v_mfma_f32_16x16x32_bf16 v[228:231], v[36:39], v[140:143], v[228:231]
  ds_read_b64_tr_b16 v[34:35], v7 offset:13856
  s_waitcnt lgkmcnt(8)
  v_mfma_f32_16x16x32_bf16 v[232:235], v[16:19], v[136:139], v[232:235]
  ds_read_b64_tr_b16 v[36:37], v7 offset:9280
  v_mfma_f32_16x16x32_bf16 v[236:239], v[16:19], v[140:143], v[236:239]
  ds_read_b64_tr_b16 v[38:39], v7 offset:13888
  s_waitcnt lgkmcnt(8)
  v_mfma_f32_16x16x32_bf16 v[240:243], v[20:23], v[136:139], v[240:243]
  ds_read_b64_tr_b16 v[16:17], v7 offset:9312
  v_mfma_f32_16x16x32_bf16 v[244:247], v[20:23], v[140:143], v[244:247]
  ds_read_b64_tr_b16 v[18:19], v7 offset:13920
  s_waitcnt lgkmcnt(8)
  v_mfma_f32_16x16x32_bf16 v[248:251], v[24:27], v[136:139], v[248:251]
  ds_read_b64_tr_b16 v[20:21], v7 offset:9344
  v_mfma_f32_16x16x32_bf16 v[252:255], v[24:27], v[140:143], v[252:255]
  ds_read_b64_tr_b16 v[22:23], v7 offset:13952
  ds_read_b32 v2, v1 offset:72
  s_waitcnt vmcnt(6)
  s_waitcnt lgkmcnt(9)
  v_mfma_f32_16x16x32_bf16 v[184:187], v[28:31], v[120:123], v[184:187]
  ds_read_b64_tr_b16 v[24:25], v7 offset:9376
  v_mfma_f32_16x16x32_bf16 v[188:191], v[28:31], v[148:151], v[188:191]
  ds_read_b64_tr_b16 v[26:27], v7 offset:13984
  s_waitcnt lgkmcnt(9)
  v_mfma_f32_16x16x32_bf16 v[192:195], v[32:35], v[120:123], v[192:195]
  ds_read_b64_tr_b16 v[28:29], v7 offset:9408
  v_mfma_f32_16x16x32_bf16 v[196:199], v[32:35], v[148:151], v[196:199]
  ds_read_b64_tr_b16 v[30:31], v7 offset:14016
  s_waitcnt lgkmcnt(9)
  v_mfma_f32_16x16x32_bf16 v[200:203], v[36:39], v[120:123], v[200:203]
  ds_read_b64_tr_b16 v[32:33], v7 offset:9440
  v_mfma_f32_16x16x32_bf16 v[204:207], v[36:39], v[148:151], v[204:207]
  ds_read_b64_tr_b16 v[34:35], v7 offset:14048
  ds_read_b32 v3, v106 offset:32
  s_waitcnt lgkmcnt(10)
  v_mfma_f32_16x16x32_bf16 v[208:211], v[16:19], v[120:123], v[208:211]
  ds_read_b64_tr_b16 v[36:37], v7 offset:9472
  v_mfma_f32_16x16x32_bf16 v[212:215], v[16:19], v[148:151], v[212:215]
  ds_read_b64_tr_b16 v[38:39], v7 offset:14080
  s_waitcnt lgkmcnt(9)
  v_readfirstlane_b32 s60, v2
  s_cmp_ge_u32 s60, 3
  s_cbranch_scc0 L_slow19
L_back20:
  v_mfma_f32_16x16x32_bf16 v[216:219], v[20:23], v[120:123], v[216:219]
  ds_read_b64_tr_b16 v[16:17], v7 offset:18432
  v_mfma_f32_16x16x32_bf16 v[220:223], v[20:23], v[148:151], v[220:223]
  ds_read_b64_tr_b16 v[18:19], v7 offset:23040
  s_waitcnt lgkmcnt(9)
  v_mfma_f32_16x16x32_bf16 v[224:227], v[24:27], v[120:123], v[224:227]
  ds_read_b64_tr_b16 v[20:21], v7 offset:18464
  v_mfma_f32_16x16x32_bf16 v[228:231], v[24:27], v[148:151], v[228:231]
  ds_read_b64_tr_b16 v[22:23], v7 offset:23072
  s_waitcnt lgkmcnt(9)
  v_mfma_f32_16x16x32_bf16 v[232:235], v[28:31], v[120:123], v[232:235]
  ds_read_b64_tr_b16 v[24:25], v7 offset:18496
  v_mfma_f32_16x16x32_bf16 v[236:239], v[28:31], v[148:151], v[236:239]
  ds_read_b64_tr_b16 v[26:27], v7 offset:23104
  s_waitcnt lgkmcnt(8)
  v_readfirstlane_b32 s60, v3
  s_cmp_ge_u32 s60, 3
  s_cbranch_scc0 L_slow21
L_back22:
  buffer_load_dwordx4 v[56:59], v9, s[28:31], s34 offen sc1
  buffer_load_dwordx4 v[60:63], v9, s[28:31], s35 offen sc1
  buffer_load_dwordx4 v[64:67], v9, s[28:31], s36 offen sc1
  v_mfma_f32_16x16x32_bf16 v[240:243], v[32:35], v[120:123], v[240:243]
  ds_read_b64_tr_b16 v[28:29], v7 offset:18528
  v_mfma_f32_16x16x32_bf16 v[244:247], v[32:35], v[148:151], v[244:247]
  ds_read_b64_tr_b16 v[30:31], v7 offset:23136
  s_waitcnt lgkmcnt(8)
  v_mfma_f32_16x16x32_bf16 v[248:251], v[36:39], v[120:123], v[248:251]
  ds_read_b64_tr_b16 v[32:33], v7 offset:18560
  v_mfma_f32_16x16x32_bf16 v[252:255], v[36:39], v[148:151], v[252:255]
  ds_read_b64_tr_b16 v[34:35], v7 offset:23168
  buffer_load_dwordx4 v[68:71], v12, s[28:31], s34 offen sc1
  buffer_load_dwordx4 v[72:75], v12, s[28:31], s35 offen sc1
  buffer_load_dwordx4 v[76:79], v12, s[28:31], s36 offen sc1
  s_waitcnt lgkmcnt(8)
  v_mfma_f32_16x16x32_bf16 v[184:187], v[16:19], v[152:155], v[184:187]
  ds_read_b64_tr_b16 v[36:37], v7 offset:18592
  v_mfma_f32_16x16x32_bf16 v[188:191], v[16:19], v[156:159], v[188:191]
  ds_read_b64_tr_b16 v[38:39], v7 offset:23200
  s_waitcnt lgkmcnt(8)
  v_mfma_f32_16x16x32_bf16 v[192:195], v[20:23], v[152:155], v[192:195]
  ds_read_b64_tr_b16 v[16:17], v7 offset:18624
  v_mfma_f32_16x16x32_bf16 v[196:199], v[20:23], v[156:159], v[196:199]
  ds_read_b64_tr_b16 v[18:19], v7 offset:23232
  buffer_load_dwordx4 v[92:95], v13, s[28:31], s34 offen sc1
  buffer_load_dwordx4 v[96:99], v13, s[28:31], s35 offen sc1
  buffer_load_dwordx4 v[100:103], v13, s[28:31], s36 offen sc1
  s_waitcnt lgkmcnt(8)
  v_mfma_f32_16x16x32_bf16 v[200:203], v[24:27], v[152:155], v[200:203]
  ds_read_b64_tr_b16 v[20:21], v7 offset:18656
  v_mfma_f32_16x16x32_bf16 v[204:207], v[24:27], v[156:159], v[204:207]
  ds_read_b64_tr_b16 v[22:23], v7 offset:23264
  s_waitcnt lgkmcnt(8)
  v_mfma_f32_16x16x32_bf16 v[208:211], v[28:31], v[152:155], v[208:211]
  ds_read_b64_tr_b16 v[24:25], v7 offset:18688
  v_mfma_f32_16x16x32_bf16 v[212:215], v[28:31], v[156:159], v[212:215]
  ds_read_b64_tr_b16 v[26:27], v7 offset:23296
  s_waitcnt lgkmcnt(8)
  v_mfma_f32_16x16x32_bf16 v[216:219], v[32:35], v[152:155], v[216:219]
  ds_read_b64_tr_b16 v[28:29], v7 offset:27648
  v_mfma_f32_16x16x32_bf16 v[220:223], v[32:35], v[156:159], v[220:223]
  ds_read_b64_tr_b16 v[30:31], v7 offset:32256
  s_waitcnt lgkmcnt(8)
  v_mfma_f32_16x16x32_bf16 v[224:227], v[36:39], v[152:155], v[224:227]
  ds_read_b64_tr_b16 v[32:33], v7 offset:27680
  v_mfma_f32_16x16x32_bf16 v[228:231], v[36:39], v[156:159], v[228:231]
  ds_read_b64_tr_b16 v[34:35], v7 offset:32288
  s_waitcnt lgkmcnt(8)
  v_mfma_f32_16x16x32_bf16 v[232:235], v[16:19], v[152:155], v[232:235]
  ds_read_b64_tr_b16 v[36:37], v7 offset:27712
  v_mfma_f32_16x16x32_bf16 v[236:239], v[16:19], v[156:159], v[236:239]
  ds_read_b64_tr_b16 v[38:39], v7 offset:32320
  s_waitcnt lgkmcnt(8)
  v_mfma_f32_16x16x32_bf16 v[240:243], v[20:23], v[152:155], v[240:243]
  ds_read_b64_tr_b16 v[16:17], v7 offset:27744
  v_mfma_f32_16x16x32_bf16 v[244:247], v[20:23], v[156:159], v[244:247]
  ds_read_b64_tr_b16 v[18:19], v7 offset:32352
  s_waitcnt lgkmcnt(8)
  v_mfma_f32_16x16x32_bf16 v[248:251], v[24:27], v[152:155], v[248:251]
  ds_read_b64_tr_b16 v[20:21], v7 offset:27776
  v_mfma_f32_16x16x32_bf16 v[252:255], v[24:27], v[156:159], v[252:255]
  ds_read_b64_tr_b16 v[22:23], v7 offset:32384
  s_waitcnt vmcnt(12)
  s_waitcnt lgkmcnt(8)
  v_mfma_f32_16x16x32_bf16 v[184:187], v[28:31], v[132:135], v[184:187]
  ds_read_b64_tr_b16 v[24:25], v7 offset:27808
  v_mfma_f32_16x16x32_bf16 v[188:191], v[28:31], v[160:163], v[188:191]
  ds_read_b64_tr_b16 v[26:27], v7 offset:32416
  s_waitcnt lgkmcnt(8)
  v_mfma_f32_16x16x32_bf16 v[192:195], v[32:35], v[132:135], v[192:195]
  ds_read_b64_tr_b16 v[28:29], v7 offset:27840
  v_mfma_f32_16x16x32_bf16 v[196:199], v[32:35], v[160:163], v[196:199]
  ds_read_b64_tr_b16 v[30:31], v7 offset:32448
  s_waitcnt lgkmcnt(8)
  v_mfma_f32_16x16x32_bf16 v[200:203], v[36:39], v[132:135], v[200:203]
  ds_read_b64_tr_b16 v[32:33], v7 offset:27872
  v_mfma_f32_16x16x32_bf16 v[204:207], v[36:39], v[160:163], v[204:207]
  ds_read_b64_tr_b16 v[34:35], v7 offset:32480
  s_waitcnt lgkmcnt(8)
  v_mfma_f32_16x16x32_bf16 v[208:211], v[16:19], v[132:135], v[208:211]
  ds_read_b64_tr_b16 v[36:37], v7 offset:27904
  v_mfma_f32_16x16x32_bf16 v[212:215], v[16:19], v[160:163], v[212:215]
  ds_read_b64_tr_b16 v[38:39], v7 offset:32512
  s_waitcnt lgkmcnt(8)
  v_mfma_f32_16x16x32_bf16 v[216:219], v[20:23], v[132:135], v[216:219]
  ds_read_b64_tr_b16 v[16:17], v7 offset:36864
  v_mfma_f32_16x16x32_bf16 v[220:223], v[20:23], v[160:163], v[220:223]
  ds_read_b64_tr_b16 v[18:19], v7 offset:41472
  s_waitcnt lgkmcnt(8)
  v_mfma_f32_16x16x32_bf16 v[224:227], v[24:27], v[132:135], v[224:227]
  ds_read_b64_tr_b16 v[20:21], v7 offset:36896
  v_mfma_f32_16x16x32_bf16 v[228:231], v[24:27], v[160:163], v[228:231]
  ds_read_b64_tr_b16 v[22:23], v7 offset:41504
  s_waitcnt lgkmcnt(8)
  v_mfma_f32_16x16x32_bf16 v[232:235], v[28:31], v[132:135], v[232:235]
  ds_read_b64_tr_b16 v[24:25], v7 offset:36928
  v_mfma_f32_16x16x32_bf16 v[236:239], v[28:31], v[160:163], v[236:239]
  ds_read_b64_tr_b16 v[26:27], v7 offset:41536
  s_waitcnt lgkmcnt(8)
  v_mfma_f32_16x16x32_bf16 v[240:243], v[32:35], v[132:135], v[240:243]
  ds_read_b64_tr_b16 v[28:29], v7 offset:36960
  v_mfma_f32_16x16x32_bf16 v[244:247], v[32:35], v[160:163], v[244:247]
  ds_read_b64_tr_b16 v[30:31], v7 offset:41568
  ds_read_b32 v4, v1 offset:76
  s_waitcnt lgkmcnt(9)
  v_mfma_f32_16x16x32_bf16 v[248:251], v[36:39], v[132:135], v[248:251]
  ds_read_b64_tr_b16 v[32:33], v7 offset:46080
  v_mfma_f32_16x16x32_bf16 v[252:255], v[36:39], v[160:163], v[252:255]
  ds_read_b64_tr_b16 v[34:35], v7 offset:50688
  s_waitcnt lgkmcnt(9)
  v_mfma_f32_16x16x32_bf16 v[184:187], v[16:19], v[164:167], v[184:187]
  ds_read_b64_tr_b16 v[36:37], v7 offset:46112
  v_mfma_f32_16x16x32_bf16 v[188:191], v[16:19], v[168:171], v[188:191]
  ds_read_b64_tr_b16 v[38:39], v7 offset:50720
  s_waitcnt lgkmcnt(9)
  v_mfma_f32_16x16x32_bf16 v[192:195], v[20:23], v[164:167], v[192:195]
  ds_read_b64_tr_b16 v[16:17], v7 offset:46144
  v_mfma_f32_16x16x32_bf16 v[196:199], v[20:23], v[168:171], v[196:199]
  ds_read_b64_tr_b16 v[18:19], v7 offset:50752
  s_waitcnt lgkmcnt(9)
  v_mfma_f32_16x16x32_bf16 v[200:203], v[24:27], v[164:167], v[200:203]
  ds_read_b64_tr_b16 v[20:21], v7 offset:46176
  v_mfma_f32_16x16x32_bf16 v[204:207], v[24:27], v[168:171], v[204:207]
  ds_read_b64_tr_b16 v[22:23], v7 offset:50784
  s_waitcnt lgkmcnt(8)
  v_readfirstlane_b32 s60, v4
  s_cmp_ge_u32 s60, 3
  s_cbranch_scc0 L_slow23
L_back24:
  v_mfma_f32_16x16x32_bf16 v[208:211], v[28:31], v[164:167], v[208:211]
  ds_read_b64_tr_b16 v[24:25], v8 offset:0
  v_mfma_f32_16x16x32_bf16 v[212:215], v[28:31], v[168:171], v[212:215]
  ds_read_b64_tr_b16 v[26:27], v8 offset:4608
  s_waitcnt vmcnt(9)
  s_waitcnt lgkmcnt(8)
  v_mfma_f32_16x16x32_bf16 v[184:187], v[32:35], v[144:147], v[184:187]
  ds_read_b64_tr_b16 v[28:29], v8 offset:32
  v_mfma_f32_16x16x32_bf16 v[188:191], v[32:35], v[172:175], v[188:191]
  ds_read_b64_tr_b16 v[30:31], v8 offset:4640
  s_waitcnt lgkmcnt(8)
  v_mfma_f32_16x16x32_bf16 v[192:195], v[36:39], v[144:147], v[192:195]
  ds_read_b64_tr_b16 v[32:33], v8 offset:64
  v_mfma_f32_16x16x32_bf16 v[196:199], v[36:39], v[172:175], v[196:199]
  ds_read_b64_tr_b16 v[34:35], v8 offset:4672
  s_waitcnt lgkmcnt(8)
  v_mfma_f32_16x16x32_bf16 v[200:203], v[16:19], v[144:147], v[200:203]
  ds_read_b64_tr_b16 v[36:37], v8 offset:96
  v_mfma_f32_16x16x32_bf16 v[204:207], v[16:19], v[172:175], v[204:207]
  ds_read_b64_tr_b16 v[38:39], v8 offset:4704
  s_waitcnt lgkmcnt(8)
  v_mfma_f32_16x16x32_bf16 v[208:211], v[20:23], v[144:147], v[208:211]
  ds_read_b64_tr_b16 v[16:17], v8 offset:9216
  v_mfma_f32_16x16x32_bf16 v[212:215], v[20:23], v[172:175], v[212:215]
  ds_read_b64_tr_b16 v[18:19], v8 offset:13824
  s_waitcnt lgkmcnt(8)
  v_mfma_f32_16x16x32_bf16 v[184:187], v[24:27], v[176:179], v[184:187]
  ds_read_b64_tr_b16 v[20:21], v8 offset:9248
  v_mfma_f32_16x16x32_bf16 v[188:191], v[24:27], v[180:183], v[188:191]
  ds_read_b64_tr_b16 v[22:23], v8 offset:13856
  s_waitcnt lgkmcnt(8)
  v_mfma_f32_16x16x32_bf16 v[192:195], v[28:31], v[176:179], v[192:195]
  ds_read_b64_tr_b16 v[24:25], v8 offset:9280
  v_mfma_f32_16x16x32_bf16 v[196:199], v[28:31], v[180:183], v[196:199]
  ds_read_b64_tr_b16 v[26:27], v8 offset:13888
  s_waitcnt lgkmcnt(8)
  v_mfma_f32_16x16x32_bf16 v[200:203], v[32:35], v[176:179], v[200:203]
  ds_read_b64_tr_b16 v[28:29], v8 offset:9312
  v_mfma_f32_16x16x32_bf16 v[204:207], v[32:35], v[180:183], v[204:207]
  ds_read_b64_tr_b16 v[30:31], v8 offset:13920
  s_waitcnt lgkmcnt(8)
  v_mfma_f32_16x16x32_bf16 v[208:211], v[36:39], v[176:179], v[208:211]
  ds_read_b64_tr_b16 v[32:33], v8 offset:18432
  v_mfma_f32_16x16x32_bf16 v[212:215], v[36:39], v[180:183], v[212:215]
  ds_read_b64_tr_b16 v[34:35], v8 offset:23040
  s_waitcnt vmcnt(6)
  v_mov_b32 v42, v64
  v_mov_b32 v43, v65
  v_mov_b32 v46, v66
  v_mov_b32 v47, v67
  s_nop 1
  s_waitcnt lgkmcnt(8)
  v_mfma_f32_16x16x32_bf16 v[184:187], v[16:19], v[56:59], v[184:187]
  ds_read_b64_tr_b16 v[36:37], v8 offset:18464
  v_mfma_f32_16x16x32_bf16 v[188:191], v[16:19], v[60:63], v[188:191]
  ds_read_b64_tr_b16 v[38:39], v8 offset:23072
  s_waitcnt lgkmcnt(8)
  v_mfma_f32_16x16x32_bf16 v[192:195], v[20:23], v[56:59], v[192:195]
  ds_read_b64_tr_b16 v[16:17], v8 offset:18496
  v_mfma_f32_16x16x32_bf16 v[196:199], v[20:23], v[60:63], v[196:199]
  ds_read_b64_tr_b16 v[18:19], v8 offset:23104
  s_waitcnt lgkmcnt(8)
  v_mfma_f32_16x16x32_bf16 v[200:203], v[24:27], v[56:59], v[200:203]
  ds_read_b64_tr_b16 v[20:21], v8 offset:18528
  v_mfma_f32_16x16x32_bf16 v[204:207], v[24:27], v[60:63], v[204:207]
  ds_read_b64_tr_b16 v[22:23], v8 offset:23136
  ds_read_b32 v2, v1 offset:80
  s_waitcnt lgkmcnt(9)
  v_mfma_f32_16x16x32_bf16 v[208:211], v[28:31], v[56:59], v[208:211]
  ds_read_b64_tr_b16 v[24:25], v8 offset:27648
  v_mfma_f32_16x16x32_bf16 v[212:215], v[28:31], v[60:63], v[212:215]
  ds_read_b64_tr_b16 v[26:27], v8 offset:32256
  s_waitcnt vmcnt(3)
  v_mov_b32 v48, v76
  v_mov_b32 v49, v77
  v_mov_b32 v52, v78
  v_mov_b32 v53, v79
  s_nop 1
  s_waitcnt lgkmcnt(9)
  v_mfma_f32_16x16x32_bf16 v[184:187], v[32:35], v[68:71], v[184:187]
  ds_read_b64_tr_b16 v[28:29], v8 offset:27680
  v_mfma_f32_16x16x32_bf16 v[188:191], v[32:35], v[72:75], v[188:191]
  ds_read_b64_tr_b16 v[30:31], v8 offset:32288
  s_waitcnt lgkmcnt(9)
  v_mfma_f32_16x16x32_bf16 v[192:195], v[36:39], v[68:71], v[192:195]
  ds_read_b64_tr_b16 v[32:33], v8 offset:27712
  v_mfma_f32_16x16x32_bf16 v[196:199], v[36:39], v[72:75], v[196:199]
  ds_read_b64_tr_b16 v[34:35], v8 offset:32320
  s_waitcnt lgkmcnt(9)
  v_mfma_f32_16x16x32_bf16 v[200:203], v[16:19], v[68:71], v[200:203]
  ds_read_b64_tr_b16 v[36:37], v8 offset:27744
  v_mfma_f32_16x16x32_bf16 v[204:207], v[16:19], v[72:75], v[204:207]
  ds_read_b64_tr_b16 v[38:39], v8 offset:32352
  s_waitcnt lgkmcnt(8)
  v_readfirstlane_b32 s60, v2
  s_cmp_ge_u32 s60, 3
  s_cbranch_scc0 L_slow25
L_back26:
  v_mfma_f32_16x16x32_bf16 v[208:211], v[20:23], v[68:71], v[208:211]
  ds_read_b64_tr_b16 v[16:17], v8 offset:36864
  v_mfma_f32_16x16x32_bf16 v[212:215], v[20:23], v[72:75], v[212:215]
  ds_read_b64_tr_b16 v[18:19], v8 offset:41472
  s_waitcnt vmcnt(0)
  v_mov_b32 v50, v100
  v_mov_b32 v51, v101
  v_mov_b32 v54, v102
  v_mov_b32 v55, v103
  s_nop 1
  s_waitcnt lgkmcnt(8)
  v_mfma_f32_16x16x32_bf16 v[184:187], v[24:27], v[92:95], v[184:187]
  ds_read_b64_tr_b16 v[20:21], v8 offset:36896
  v_mfma_f32_16x16x32_bf16 v[188:191], v[24:27], v[96:99], v[188:191]
  ds_read_b64_tr_b16 v[22:23], v8 offset:41504
  s_waitcnt lgkmcnt(8)
  v_mfma_f32_16x16x32_bf16 v[192:195], v[28:31], v[92:95], v[192:195]
  ds_read_b64_tr_b16 v[24:25], v8 offset:36928
  v_mfma_f32_16x16x32_bf16 v[196:199], v[28:31], v[96:99], v[196:199]
  ds_read_b64_tr_b16 v[26:27], v8 offset:41536
  s_waitcnt lgkmcnt(8)
  v_mfma_f32_16x16x32_bf16 v[200:203], v[32:35], v[92:95], v[200:203]
  ds_read_b64_tr_b16 v[28:29], v8 offset:36960
  v_mfma_f32_16x16x32_bf16 v[204:207], v[32:35], v[96:99], v[204:207]
  ds_read_b64_tr_b16 v[30:31], v8 offset:41568
  s_waitcnt lgkmcnt(8)
  v_mfma_f32_16x16x32_bf16 v[208:211], v[36:39], v[92:95], v[208:211]
  ds_read_b64_tr_b16 v[32:33], v6 offset:0
  v_mfma_f32_16x16x32_bf16 v[212:215], v[36:39], v[96:99], v[212:215]
  ds_read_b64_tr_b16 v[34:35], v6 offset:4608
  s_waitcnt lgkmcnt(8)
  v_mfma_f32_16x16x32_bf16 v[184:187], v[16:19], v[40:43], v[184:187]
  ds_read_b64_tr_b16 v[36:37], v6 offset:32
  v_mfma_f32_16x16x32_bf16 v[188:191], v[16:19], v[44:47], v[188:191]
  ds_read_b64_tr_b16 v[38:39], v6 offset:4640
  s_waitcnt lgkmcnt(8)
  v_mfma_f32_16x16x32_bf16 v[192:195], v[20:23], v[40:43], v[192:195]
  ds_read_b64_tr_b16 v[16:17], v6 offset:64
  v_mfma_f32_16x16x32_bf16 v[196:199], v[20:23], v[44:47], v[196:199]
  ds_read_b64_tr_b16 v[18:19], v6 offset:4672
  s_waitcnt lgkmcnt(8)
  v_mfma_f32_16x16x32_bf16 v[200:203], v[24:27], v[40:43], v[200:203]
  ds_read_b64_tr_b16 v[20:21], v6 offset:96
  v_mfma_f32_16x16x32_bf16 v[204:207], v[24:27], v[44:47], v[204:207]
  ds_read_b64_tr_b16 v[22:23], v6 offset:4704
  s_waitcnt lgkmcnt(8)
  v_mfma_f32_16x16x32_bf16 v[208:211], v[28:31], v[40:43], v[208:211]
  ds_read_b64_tr_b16 v[24:25], v7 offset:36992
  v_mfma_f32_16x16x32_bf16 v[212:215], v[28:31], v[44:47], v[212:215]
  ds_read_b64_tr_b16 v[26:27], v7 offset:41600
  s_waitcnt lgkmcnt(8)
  v_mfma_f32_16x16x32_bf16 v[184:187], v[32:35], v[48:51], v[184:187]
  ds_read_b64_tr_b16 v[28:29], v7 offset:37024
  v_mfma_f32_16x16x32_bf16 v[188:191], v[32:35], v[52:55], v[188:191]
  ds_read_b64_tr_b16 v[30:31], v7 offset:41632
  s_waitcnt lgkmcnt(8)
  v_mfma_f32_16x16x32_bf16 v[192:195], v[36:39], v[48:51], v[192:195]
  ds_read_b64_tr_b16 v[32:33], v7 offset:46208
  v_mfma_f32_16x16x32_bf16 v[196:199], v[36:39], v[52:55], v[196:199]
  ds_read_b64_tr_b16 v[34:35], v7 offset:50816
  s_waitcnt lgkmcnt(8)
  v_mfma_f32_16x16x32_bf16 v[200:203], v[16:19], v[48:51], v[200:203]
  ds_read_b64_tr_b16 v[36:37], v7 offset:46240
  v_mfma_f32_16x16x32_bf16 v[204:207], v[16:19], v[52:55], v[204:207]
  ds_read_b64_tr_b16 v[38:39], v7 offset:50848
  s_waitcnt lgkmcnt(8)
  v_mfma_f32_16x16x32_bf16 v[208:211], v[20:23], v[48:51], v[208:211]
  ds_read_b64_tr_b16 v[16:17], v8 offset:128
  v_mfma_f32_16x16x32_bf16 v[212:215], v[20:23], v[52:55], v[212:215]
  ds_read_b64_tr_b16 v[18:19], v8 offset:4736
  s_waitcnt lgkmcnt(8)
  v_mfma_f32_16x16x32_bf16 v[216:219], v[24:27], v[164:167], v[216:219]
  ds_read_b64_tr_b16 v[20:21], v8 offset:160
  v_mfma_f32_16x16x32_bf16 v[220:223], v[24:27], v[168:171], v[220:223]
  ds_read_b64_tr_b16 v[22:23], v8 offset:4768
  s_waitcnt lgkmcnt(8)
  v_mfma_f32_16x16x32_bf16 v[224:227], v[28:31], v[164:167], v[224:227]
  ds_read_b64_tr_b16 v[24:25], v8 offset:9344
  v_mfma_f32_16x16x32_bf16 v[228:231], v[28:31], v[168:171], v[228:231]
  ds_read_b64_tr_b16 v[26:27], v8 offset:13952
  s_waitcnt lgkmcnt(8)
  v_mfma_f32_16x16x32_bf16 v[216:219], v[32:35], v[144:147], v[216:219]
  ds_read_b64_tr_b16 v[28:29], v8 offset:9376
  v_mfma_f32_16x16x32_bf16 v[220:223], v[32:35], v[172:175], v[220:223]
  ds_read_b64_tr_b16 v[30:31], v8 offset:13984
  v_cvt_pk_bf16_f32 v112, v184, v185
  v_cvt_pk_bf16_f32 v113, v186, v187
  v_cvt_pk_bf16_f32 v114, v192, v193
  v_cvt_pk_bf16_f32 v115, v194, v195
  v_cvt_pk_bf16_f32 v116, v200, v201
  v_cvt_pk_bf16_f32 v117, v202, v203
  v_cvt_pk_bf16_f32 v118, v208, v209
  v_cvt_pk_bf16_f32 v119, v210, v211
  s_cmp_eq_u32 s49, 0
  s_cbranch_scc1 L_own27
  buffer_store_dwordx4 v[112:115], v5, s[44:47], s24 offen sc1
  buffer_store_dwordx4 v[116:119], v5, s[44:47], s25 offen sc1
L_ownb28:
  v_cvt_pk_bf16_f32 v124, v188, v189
  v_cvt_pk_bf16_f32 v125, v190, v191
  v_cvt_pk_bf16_f32 v126, v196, v197
  v_cvt_pk_bf16_f32 v127, v198, v199
  v_cvt_pk_bf16_f32 v128, v204, v205
  v_cvt_pk_bf16_f32 v129, v206, v207
  v_cvt_pk_bf16_f32 v130, v212, v213
  v_cvt_pk_bf16_f32 v131, v214, v215
  s_cmp_eq_u32 s49, 1
  s_cbranch_scc1 L_own29
  buffer_store_dwordx4 v[124:127], v5, s[44:47], s26 offen sc1
  buffer_store_dwordx4 v[128:131], v5, s[44:47], s27 offen sc1
L_ownb30:
  s_mov_b64 exec, 1
  ds_add_u32 v1, v10 offset:16
  s_mov_b64 exec, -1
  s_waitcnt lgkmcnt(9)
  v_mfma_f32_16x16x32_bf16 v[224:227], v[36:39], v[144:147], v[224:227]
  ds_read_b64_tr_b16 v[32:33], v8 offset:18560
  v_mfma_f32_16x16x32_bf16 v[228:231], v[36:39], v[172:175], v[228:231]
  ds_read_b64_tr_b16 v[34:35], v8 offset:23168
  s_waitcnt lgkmcnt(9)
  v_mfma_f32_16x16x32_bf16 v[216:219], v[16:19], v[176:179], v[216:219]
  ds_read_b64_tr_b16 v[36:37], v8 offset:18592
  v_mfma_f32_16x16x32_bf16 v[220:223], v[16:19], v[180:183], v[220:223]
  ds_read_b64_tr_b16 v[38:39], v8 offset:23200
  s_waitcnt lgkmcnt(9)
  v_mfma_f32_16x16x32_bf16 v[224:227], v[20:23], v[176:179], v[224:227]
  ds_read_b64_tr_b16 v[16:17], v8 offset:27776
  v_mfma_f32_16x16x32_bf16 v[228:231], v[20:23], v[180:183], v[228:231]
  ds_read_b64_tr_b16 v[18:19], v8 offset:32384
  s_waitcnt lgkmcnt(9)
  v_mfma_f32_16x16x32_bf16 v[216:219], v[24:27], v[56:59], v[216:219]
  ds_read_b64_tr_b16 v[20:21], v8 offset:27808
  v_mfma_f32_16x16x32_bf16 v[220:223], v[24:27], v[60:63], v[220:223]
  ds_read_b64_tr_b16 v[22:23], v8 offset:32416
  s_waitcnt lgkmcnt(9)
  v_mfma_f32_16x16x32_bf16 v[224:227], v[28:31], v[56:59], v[224:227]
  ds_read_b64_tr_b16 v[24:25], v8 offset:36992
  v_mfma_f32_16x16x32_bf16 v[228:231], v[28:31], v[60:63], v[228:231]
  ds_read_b64_tr_b16 v[26:27], v8 offset:41600
  s_waitcnt lgkmcnt(8)
  v_mfma_f32_16x16x32_bf16 v[216:219], v[32:35], v[68:71], v[216:219]
  ds_read_b64_tr_b16 v[28:29], v8 offset:37024
  v_mfma_f32_16x16x32_bf16 v[220:223], v[32:35], v[72:75], v[220:223]
  ds_read_b64_tr_b16 v[30:31], v8 offset:41632
  s_waitcnt lgkmcnt(8)
  v_mfma_f32_16x16x32_bf16 v[224:227], v[36:39], v[68:71], v[224:227]
  ds_read_b64_tr_b16 v[32:33], v6 offset:128
  v_mfma_f32_16x16x32_bf16 v[228:231], v[36:39], v[72:75], v[228:231]
  ds_read_b64_tr_b16 v[34:35], v6 offset:4736
  s_waitcnt lgkmcnt(8)
  v_mfma_f32_16x16x32_bf16 v[216:219], v[16:19], v[92:95], v[216:219]
  ds_read_b64_tr_b16 v[36:37], v6 offset:160
  v_mfma_f32_16x16x32_bf16 v[220:223], v[16:19], v[96:99], v[220:223]
  ds_read_b64_tr_b16 v[38:39], v6 offset:4768
  s_waitcnt lgkmcnt(8)
  v_mfma_f32_16x16x32_bf16 v[224:227], v[20:23], v[92:95], v[224:227]
  ds_read_b64_tr_b16 v[16:17], v7 offset:37056
  v_mfma_f32_16x16x32_bf16 v[228:231], v[20:23], v[96:99], v[228:231]
  ds_read_b64_tr_b16 v[18:19], v7 offset:41664
  s_waitcnt lgkmcnt(8)
  v_mfma_f32_16x16x32_bf16 v[216:219], v[24:27], v[40:43], v[216:219]
  ds_read_b64_tr_b16 v[20:21], v7 offset:37088
  v_mfma_f32_16x16x32_bf16 v[220:223], v[24:27], v[44:47], v[220:223]
  ds_read_b64_tr_b16 v[22:23], v7 offset:41696
  s_waitcnt lgkmcnt(8)
  v_mfma_f32_16x16x32_bf16 v[224:227], v[28:31], v[40:43], v[224:227]
  ds_read_b64_tr_b16 v[24:25], v7 offset:37120
  v_mfma_f32_16x16x32_bf16 v[228:231], v[28:31], v[44:47], v[228:231]
  ds_read_b64_tr_b16 v[26:27], v7 offset:41728
  s_waitcnt lgkmcnt(8)
  v_mfma_f32_16x16x32_bf16 v[216:219], v[32:35], v[48:51], v[216:219]
  ds_read_b64_tr_b16 v[28:29], v7 offset:46272
  v_mfma_f32_16x16x32_bf16 v[220:223], v[32:35], v[52:55], v[220:223]
  ds_read_b64_tr_b16 v[30:31], v7 offset:50880
  s_waitcnt lgkmcnt(8)
  v_mfma_f32_16x16x32_bf16 v[224:227], v[36:39], v[48:51], v[224:227]
  ds_read_b64_tr_b16 v[32:33], v7 offset:46304
  v_mfma_f32_16x16x32_bf16 v[228:231], v[36:39], v[52:55], v[228:231]
  ds_read_b64_tr_b16 v[34:35], v7 offset:50912
  s_waitcnt lgkmcnt(8)
  v_mfma_f32_16x16x32_bf16 v[232:235], v[16:19], v[164:167], v[232:235]
  ds_read_b64_tr_b16 v[36:37], v7 offset:46336
  v_mfma_f32_16x16x32_bf16 v[236:239], v[16:19], v[168:171], v[236:239]
  ds_read_b64_tr_b16 v[38:39], v7 offset:50944
  s_waitcnt lgkmcnt(8)
  v_mfma_f32_16x16x32_bf16 v[240:243], v[20:23], v[164:167], v[240:243]
  ds_read_b64_tr_b16 v[16:17], v8 offset:192
  v_mfma_f32_16x16x32_bf16 v[244:247], v[20:23], v[168:171], v[244:247]
  ds_read_b64_tr_b16 v[18:19], v8 offset:4800
  s_waitcnt lgkmcnt(8)
  v_mfma_f32_16x16x32_bf16 v[248:251], v[24:27], v[164:167], v[248:251]
  ds_read_b64_tr_b16 v[20:21], v8 offset:224
  v_mfma_f32_16x16x32_bf16 v[252:255], v[24:27], v[168:171], v[252:255]
  ds_read_b64_tr_b16 v[22:23], v8 offset:4832
  v_cvt_pk_bf16_f32 v136, v216, v217
  v_cvt_pk_bf16_f32 v137, v218, v219
  v_cvt_pk_bf16_f32 v138, v224, v225
  v_cvt_pk_bf16_f32 v139, v226, v227
  s_cmp_eq_u32 s49, 0
  s_cbranch_scc1 L_own31
  buffer_store_dwordx4 v[136:139], v5, s[44:47], s32 offen sc1
L_ownb32:
  v_cvt_pk_bf16_f32 v140, v220, v221
  v_cvt_pk_bf16_f32 v141, v222, v223
  v_cvt_pk_bf16_f32 v142, v228, v229
  v_cvt_pk_bf16_f32 v143, v230, v231
  s_cmp_eq_u32 s49, 1
  s_cbranch_scc1 L_own33
  buffer_store_dwordx4 v[140:143], v5, s[44:47], s33 offen sc1
L_ownb34:
  v_mov_b32 v115, v11
  v_mov_b32 v119, v11
  v_mov_b32 v127, v11
  v_mov_b32 v131, v11
  s_mov_b64 exec, 1
  ds_add_u32 v1, v10 offset:20
  s_mov_b64 exec, -1
  s_waitcnt lgkmcnt(9)
  v_mfma_f32_16x16x32_bf16 v[232:235], v[28:31], v[144:147], v[232:235]
  ds_read_b64_tr_b16 v[24:25], v8 offset:256
  v_mfma_f32_16x16x32_bf16 v[236:239], v[28:31], v[172:175], v[236:239]
  ds_read_b64_tr_b16 v[26:27], v8 offset:4864
  s_waitcnt lgkmcnt(9)
  v_mfma_f32_16x16x32_bf16 v[240:243], v[32:35], v[144:147], v[240:243]
  ds_read_b64_tr_b16 v[28:29], v8 offset:9408
  v_mfma_f32_16x16x32_bf16 v[244:247], v[32:35], v[172:175], v[244:247]
  ds_read_b64_tr_b16 v[30:31], v8 offset:14016
  s_waitcnt lgkmcnt(9)
  v_mfma_f32_16x16x32_bf16 v[248:251], v[36:39], v[144:147], v[248:251]
  ds_read_b64_tr_b16 v[32:33], v8 offset:9440
  v_mfma_f32_16x16x32_bf16 v[252:255], v[36:39], v[172:175], v[252:255]
  ds_read_b64_tr_b16 v[34:35], v8 offset:14048
  s_waitcnt lgkmcnt(9)
  v_mfma_f32_16x16x32_bf16 v[232:235], v[16:19], v[176:179], v[232:235]
  ds_read_b64_tr_b16 v[36:37], v8 offset:9472
  v_mfma_f32_16x16x32_bf16 v[236:239], v[16:19], v[180:183], v[236:239]
  ds_read_b64_tr_b16 v[38:39], v8 offset:14080
  s_waitcnt lgkmcnt(9)
  v_mfma_f32_16x16x32_bf16 v[240:243], v[20:23], v[176:179], v[240:243]
  ds_read_b64_tr_b16 v[16:17], v8 offset:18624
  v_mfma_f32_16x16x32_bf16 v[244:247], v[20:23], v[180:183], v[244:247]
  ds_read_b64_tr_b16 v[18:19], v8 offset:23232
  s_waitcnt lgkmcnt(8)
  v_mfma_f32_16x16x32_bf16 v[248:251], v[24:27], v[176:179], v[248:251]
  ds_read_b64_tr_b16 v[20:21], v8 offset:18656
  v_mfma_f32_16x16x32_bf16 v[252:255], v[24:27], v[180:183], v[252:255]
  ds_read_b64_tr_b16 v[22:23], v8 offset:23264
  s_waitcnt lgkmcnt(8)
  v_mfma_f32_16x16x32_bf16 v[232:235], v[28:31], v[56:59], v[232:235]
  ds_read_b64_tr_b16 v[24:25], v8 offset:18688
  v_mfma_f32_16x16x32_bf16 v[236:239], v[28:31], v[60:63], v[236:239]
  ds_read_b64_tr_b16 v[26:27], v8 offset:23296
  s_waitcnt lgkmcnt(8)
  v_mfma_f32_16x16x32_bf16 v[240:243], v[32:35], v[56:59], v[240:243]
  ds_read_b64_tr_b16 v[28:29], v8 offset:27840
  v_mfma_f32_16x16x32_bf16 v[244:247], v[32:35], v[60:63], v[244:247]
  ds_read_b64_tr_b16 v[30:31], v8 offset:32448
  s_waitcnt lgkmcnt(8)
  v_mfma_f32_16x16x32_bf16 v[248:251], v[36:39], v[56:59], v[248:251]
  ds_read_b64_tr_b16 v[32:33], v8 offset:27872
  v_mfma_f32_16x16x32_bf16 v[252:255], v[36:39], v[60:63], v[252:255]
  ds_read_b64_tr_b16 v[34:35], v8 offset:32480
  s_waitcnt lgkmcnt(8)
  v_mfma_f32_16x16x32_bf16 v[232:235], v[16:19], v[68:71], v[232:235]
  ds_read_b64_tr_b16 v[36:37], v8 offset:27904
  v_mfma_f32_16x16x32_bf16 v[236:239], v[16:19], v[72:75], v[236:239]
  ds_read_b64_tr_b16 v[38:39], v8 offset:32512
  s_waitcnt lgkmcnt(8)
  v_mfma_f32_16x16x32_bf16 v[240:243], v[20:23], v[68:71], v[240:243]
  ds_read_b64_tr_b16 v[16:17], v8 offset:37056
  v_mfma_f32_16x16x32_bf16 v[244:247], v[20:23], v[72:75], v[244:247]
  ds_read_b64_tr_b16 v[18:19], v8 offset:41664
  s_waitcnt lgkmcnt(8)
  v_mfma_f32_16x16x32_bf16 v[248:251], v[24:27], v[68:71], v[248:251]
  ds_read_b64_tr_b16 v[20:21], v8 offset:37088
  v_mfma_f32_16x16x32_bf16 v[252:255], v[24:27], v[72:75], v[252:255]
  ds_read_b64_tr_b16 v[22:23], v8 offset:41696
  s_waitcnt lgkmcnt(8)
  v_mfma_f32_16x16x32_bf16 v[232:235], v[28:31], v[92:95], v[232:235]
  ds_read_b64_tr_b16 v[24:25], v8 offset:37120
  v_mfma_f32_16x16x32_bf16 v[236:239], v[28:31], v[96:99], v[236:239]
  ds_read_b64_tr_b16 v[26:27], v8 offset:41728
  s_waitcnt lgkmcnt(8)
  v_mfma_f32_16x16x32_bf16 v[240:243], v[32:35], v[92:95], v[240:243]
  ds_read_b64_tr_b16 v[28:29], v6 offset:192
  v_mfma_f32_16x16x32_bf16 v[244:247], v[32:35], v[96:99], v[244:247]
  ds_read_b64_tr_b16 v[30:31], v6 offset:4800
  s_waitcnt vmcnt(1)
  v_add_u32 v104, 4, v11
  s_mov_b64 exec, 1
  buffer_store_dword v104, v105, s[28:31], s43 offen offset:0 sc1
  s_mov_b64 exec, -1
  s_waitcnt lgkmcnt(8)
  v_mfma_f32_16x16x32_bf16 v[248:251], v[36:39], v[92:95], v[248:251]
  ds_read_b64_tr_b16 v[32:33], v6 offset:224
  v_mfma_f32_16x16x32_bf16 v[252:255], v[36:39], v[96:99], v[252:255]
  ds_read_b64_tr_b16 v[34:35], v6 offset:4832
  s_waitcnt lgkmcnt(8)
  v_mfma_f32_16x16x32_bf16 v[232:235], v[16:19], v[40:43], v[232:235]
  ds_read_b64_tr_b16 v[36:37], v6 offset:256
  v_mfma_f32_16x16x32_bf16 v[236:239], v[16:19], v[44:47], v[236:239]
  ds_read_b64_tr_b16 v[38:39], v6 offset:4864
  s_waitcnt lgkmcnt(8)
  v_mfma_f32_16x16x32_bf16 v[240:243], v[20:23], v[40:43], v[240:243]
  v_mfma_f32_16x16x32_bf16 v[244:247], v[20:23], v[44:47], v[244:247]
  s_waitcnt lgkmcnt(6)
  v_mfma_f32_16x16x32_bf16 v[248:251], v[24:27], v[40:43], v[248:251]
  v_mfma_f32_16x16x32_bf16 v[252:255], v[24:27], v[44:47], v[252:255]
  s_waitcnt lgkmcnt(4)
  v_mfma_f32_16x16x32_bf16 v[232:235], v[28:31], v[48:51], v[232:235]
  v_mfma_f32_16x16x32_bf16 v[236:239], v[28:31], v[52:55], v[236:239]
  s_waitcnt lgkmcnt(2)
  v_mfma_f32_16x16x32_bf16 v[240:243], v[32:35], v[48:51], v[240:243]
  v_mfma_f32_16x16x32_bf16 v[244:247], v[32:35], v[52:55], v[244:247]
  s_waitcnt lgkmcnt(0)
  v_mfma_f32_16x16x32_bf16 v[248:251], v[36:39], v[48:51], v[248:251]
  v_mfma_f32_16x16x32_bf16 v[252:255], v[36:39], v[52:55], v[252:255]
  s_nop 7
  v_cvt_pk_bf16_f32 v112, v232, v233
  v_cvt_pk_bf16_f32 v113, v234, v235
  v_cvt_pk_bf16_f32 v114, v240, v241
  v_cvt_pk_bf16_f32 v116, v242, v243
  v_cvt_pk_bf16_f32 v117, v248, v249
  v_cvt_pk_bf16_f32 v118, v250, v251
  s_cmp_eq_u32 s49, 0
  s_cbranch_scc1 L_own35
  buffer_store_dwordx4 v[112:115], v5, s[44:47], s34 offen sc1
  buffer_store_dwordx4 v[116:119], v5, s[44:47], s35 offen sc1
L_ownb36:
  v_cvt_pk_bf16_f32 v124, v236, v237
  v_cvt_pk_bf16_f32 v125, v238, v239
  v_cvt_pk_bf16_f32 v126, v244, v245
  v_cvt_pk_bf16_f32 v128, v246, v247
  v_cvt_pk_bf16_f32 v129, v252, v253
  v_cvt_pk_bf16_f32 v130, v254, v255
  s_cmp_eq_u32 s49, 1
  s_cbranch_scc1 L_own37
  buffer_store_dwordx4 v[124:127], v5, s[44:47], s36 offen sc1
  buffer_store_dwordx4 v[128:131], v5, s[44:47], s37 offen sc1
L_ownb38:
  v_add_u32 v104, 6, v11
  s_mov_b64 exec, 1
  buffer_store_dword v104, v105, s[28:31], s43 offen offset:64 sc1
  s_mov_b64 exec, -1
  s_mov_b64 exec, 1
  ds_add_u32 v1, v10 offset:24
  s_mov_b64 exec, -1
  s_waitcnt vmcnt(3)
  v_add_u32 v104, 5, v11
  s_mov_b64 exec, 1
  buffer_store_dword v104, v105, s[28:31], s43 offen offset:0 sc1
  s_mov_b64 exec, -1
L_fin:
L_end:
  s_endpgm
L_slow11:
  s_mov_b32 s61, 3200000
L_sp39:
  ds_read_b32 v4, v1 offset:64
  s_sub_u32 s61, s61, 1
  s_waitcnt lgkmcnt(0)
  v_readfirstlane_b32 s60, v4
  s_cmp_eq_u32 s61, 0
  s_cbranch_scc1 L_spd40
  s_cmp_ge_u32 s60, 3
  s_cbranch_scc0 L_sp39
L_spd40:
  s_branch L_back12
L_slow13:
  s_mov_b32 s61, 3200000
L_sp41:
  ds_read_b32 v2, v106 offset:32
  s_sub_u32 s61, s61, 1
  s_waitcnt lgkmcnt(0)
  v_readfirstlane_b32 s60, v2
  s_cmp_eq_u32 s61, 0
  s_cbranch_scc1 L_spd42
  s_cmp_ge_u32 s60, 1
  s_cbranch_scc0 L_sp41
L_spd42:
  s_branch L_back14
L_slow15:
  s_mov_b32 s61, 3200000
L_sp43:
  ds_read_b32 v3, v1 offset:68
  s_sub_u32 s61, s61, 1
  s_waitcnt lgkmcnt(0)
  v_readfirstlane_b32 s60, v3
  s_cmp_eq_u32 s61, 0
  s_cbranch_scc1 L_spd44
  s_cmp_ge_u32 s60, 3
  s_cbranch_scc0 L_sp43
L_spd44:
  s_branch L_back16
L_slow17:
  s_mov_b32 s61, 3200000
L_sp45:
  ds_read_b32 v4, v106 offset:32
  s_sub_u32 s61, s61, 1
  s_waitcnt lgkmcnt(0)
  v_readfirstlane_b32 s60, v4
  s_cmp_eq_u32 s61, 0
  s_cbranch_scc1 L_spd46
  s_cmp_ge_u32 s60, 2
  s_cbranch_scc0 L_sp45
L_spd46:
  s_branch L_back18
L_slow19:
  s_mov_b32 s61, 3200000
L_sp47:
  ds_read_b32 v2, v1 offset:72
  s_sub_u32 s61, s61, 1
  s_waitcnt lgkmcnt(0)
  v_readfirstlane_b32 s60, v2
  s_cmp_eq_u32 s61, 0
  s_cbranch_scc1 L_spd48
  s_cmp_ge_u32 s60, 3
  s_cbranch_scc0 L_sp47
L_spd48:
  s_branch L_back20
L_slow21:
  s_mov_b32 s61, 3200000
L_sp49:
  ds_read_b32 v3, v106 offset:32
  s_sub_u32 s61, s61, 1
  s_waitcnt lgkmcnt(0)
  v_readfirstlane_b32 s60, v3
  s_cmp_eq_u32 s61, 0
  s_cbranch_scc1 L_spd50
  s_cmp_ge_u32 s60, 3
  s_cbranch_scc0 L_sp49
L_spd50:
  s_branch L_back22
L_slow23:
  s_mov_b32 s61, 3200000
L_sp51:
  ds_read_b32 v4, v1 offset:76
  s_sub_u32 s61, s61, 1
  s_waitcnt lgkmcnt(0)
  v_readfirstlane_b32 s60, v4
  s_cmp_eq_u32 s61, 0
  s_cbranch_scc1 L_spd52
  s_cmp_ge_u32 s60, 3
  s_cbranch_scc0 L_sp51
L_spd52:
  s_branch L_back24
L_slow25:
  s_mov_b32 s61, 3200000
L_sp53:
  ds_read_b32 v2, v1 offset:80
  s_sub_u32 s61, s61, 1
  s_waitcnt lgkmcnt(0)
  v_readfirstlane_b32 s60, v2
  s_cmp_eq_u32 s61, 0
  s_cbranch_scc1 L_spd54
  s_cmp_ge_u32 s60, 3
  s_cbranch_scc0 L_sp53
L_spd54:
  s_branch L_back26
L_own27:
  ds_write_b128 v107, v[112:115] offset:0
  ds_write_b128 v107, v[116:119] offset:1024
  s_branch L_ownb28
L_own29:
  ds_write_b128 v107, v[124:127] offset:0
  ds_write_b128 v107, v[128:131] offset:1024
  s_branch L_ownb30
L_own31:
  ds_write_b128 v107, v[136:139] offset:2048
  s_branch L_ownb32
L_own33:
  ds_write_b128 v107, v[140:143] offset:2048
  s_branch L_ownb34
L_own35:
  ds_write_b128 v107, v[112:115] offset:3072
  ds_write_b128 v107, v[116:119] offset:4096
  s_branch L_ownb36
L_own37:
  ds_write_b128 v107, v[124:127] offset:3072
  ds_write_b128 v107, v[128:131] offset:4096
  s_branch L_ownb38
L_codeend:
.section .rodata,"a"
.p2align 6
.amdhsa_kernel standalone__geglu_ffn__sampling_kernel
  .amdhsa_next_free_vgpr 256
  .amdhsa_next_free_sgpr 102
  .amdhsa_accum_offset 256
  .amdhsa_group_segment_fixed_size 0
  .amdhsa_kernarg_size 56
  .amdhsa_user_sgpr_count 2
  .amdhsa_user_sgpr_kernarg_segment_ptr 1
  .amdhsa_system_sgpr_workgroup_id_x 1
.end_amdhsa_kernel
```
